```python
import torch

def _softmax(x, axis=-1):
    return torch.softmax(x, dim=axis)
def _gelu(x):
    return torch.nn.functional.gelu(x, approximate="tanh")
def _silu(x):
    return torch.nn.functional.silu(x)
def _sigmoid(x):
    return torch.sigmoid(x)
def _layernorm(x, axis=-1, eps=1e-5):
    m = x.mean(dim=axis, keepdim=True)
    v = x.var(dim=axis, keepdim=True, unbiased=False)
    return (x - m) / torch.sqrt(v + eps)
def _scatter_add(tgt, idx, src, axis=0):
    return tgt.clone().index_add_(axis, idx, src)
def _segment_sum(src, seg, n):
    out = torch.zeros((n,) + src.shape[1:], dtype=src.dtype)
    return out.index_add_(0, seg, src)
def _pad(x, pw):
    flat = tuple(v for pair in reversed(pw) for v in pair)
    return torch.nn.functional.pad(x, flat)

kernel_name = 'sequential_preLN__ssm_conv_h3__dense_activation_silu__prompt'

def setup_inputs():

    _w = (lambda a: (lambda t: t.to(torch.bfloat16) if t.is_floating_point() else t)(torch.as_tensor(a)))
    def _A_setup():
        B, S, D = 1, 2048, 512
        ks = 4
        return {
            "q": _w((lambda *s: torch.randn(*s, dtype=torch.bfloat16) * 0.05)(B, S, D)),
            "k": _w((lambda *s: torch.randn(*s, dtype=torch.bfloat16) * 0.2)(B, S, D)),
            "v": _w((lambda *s: torch.randn(*s, dtype=torch.bfloat16) * 0.2)(B, S, D)),
            "shift_k": _w((lambda *s: torch.randn(*s, dtype=torch.bfloat16) * 0.2)(D, ks) * 0.5),
            "ssm_k": _w((lambda *s: torch.randn(*s, dtype=torch.bfloat16) * 0.4)(D, S) * (1.0 / S ** 0.5)),
            "ssm_D": _w((lambda *s: torch.randn(*s, dtype=torch.bfloat16) * 0.2)(D)),
        }
    _A_in = _A_setup()

    def _B_setup():
        B, S, D, F = 1, 2048, 512, 1792
        return {
            "x": _w((lambda *s: torch.randn(*s, dtype=torch.bfloat16) * 0.05)(B, S, D)),
            "w1": _w((lambda *s: torch.randn(*s, dtype=torch.bfloat16) * 0.8)(D, F) * (D ** -0.5)),
            "w2": _w((lambda *s: torch.randn(*s, dtype=torch.bfloat16) * 0.1)(F, D) * (F ** -0.5)),
        }
    _B_in = _B_setup()

    return {
        "A_q": _A_in["q"],
        "A_k": _A_in["k"],
        "A_v": _A_in["v"],
        "A_shift_k": _A_in["shift_k"],
        "A_ssm_k": _A_in["ssm_k"],
        "A_ssm_D": _A_in["ssm_D"],
        "B_x": _B_in["x"],
        "B_w1": _B_in["w1"],
        "B_w2": _B_in["w2"],
    }

def reference(A_q, A_k, A_v, A_shift_k, A_ssm_k, A_ssm_D, B_x, B_w1, B_w2):
    def _A_ref(q, k, v, shift_k, ssm_k, ssm_D):
        B, S, D = q.shape
        ks = shift_k.shape[-1]
        k_pad = _pad(k, ((0, 0), (ks - 1, 0), (0, 0)))
        k_shift = torch.zeros_like(k)
        for t in range(ks):
            k_shift = k_shift + k_pad[:, t:t + S, :] * shift_k[:, ks - 1 - t][None, None, :]
        kv = k_shift * v
        L = 2 * S
        kv_pad = _pad(kv, ((0, 0), (0, S), (0, 0)))
        kf_pad = _pad(ssm_k, ((0, 0), (0, S)))
        kv_f = (lambda x, axes=(-2,-1): torch.fft.rfft2(x.float(), dim=axes))(kv_pad[:, None, :, :], axes=(1, 2))
        kf_f = (lambda x, axes=(-2,-1): torch.fft.rfft2(x.float(), dim=axes))(kf_pad[:, None, :], axes=(1, 2))
        kf_f = (lambda x, *d: x.permute(*d))(kf_f, 1, 2, 0)
        y_f = kv_f * kf_f[None, :, :, :]
        y = (lambda x, s, axes=(-2,-1): torch.fft.irfft2(x, s=s, dim=axes).to(torch.bfloat16))(y_f, (1, L), axes=(1, 2))[:, 0, :S, :]
        y = y + kv * ssm_D[None, None, :]
        return q * y

    def _B_ref(x, w1, w2):
        h = torch.einsum("bsd,df->bsf", x, w1)
        h = _silu(h)
        out = torch.einsum("bsf,fd->bsd", h, w2)
        return out

    x = A_q
    h = x + _A_ref(_layernorm(x, axis=-1), A_k, A_v, A_shift_k, A_ssm_k, A_ssm_D)
    h2 = h + _B_ref(_layernorm(h, axis=-1), B_w1, B_w2)
    return h2
```

```asm
; @launch grid=(256,1,1) block=(256,1,1) lds=163840
.amdgcn_target "amdgcn-amd-amdhsa--gfx950"
.text
.globl sequential_preLN__ssm_conv_h3__dense_activation_silu__prompt_kernel
.p2align 8
.type sequential_preLN__ssm_conv_h3__dense_activation_silu__prompt_kernel,@function
sequential_preLN__ssm_conv_h3__dense_activation_silu__prompt_kernel:
K_START:
    s_cmp_ge_u32 s2, 256
    s_cbranch_scc1 K_END
    s_load_dwordx16 s[4:19], s[0:1], 0
    s_load_dwordx8 s[20:27], s[0:1], 64
    s_and_b32 s68, s2, 7
    s_lshr_b32 s69, s2, 3
    v_and_b32 v182, 15, v0
    v_bfe_u32 v183, v0, 4, 2
    v_bfe_u32 v184, v0, 6, 1
    v_lshrrev_b32 v185, 7, v0
    s_lshl_b32 s71, s69, 6
    s_lshl_b32 s72, s68, 7
    v_lshlrev_b32 v186, 3, v183
    v_lshl_add_u32 v186, v185, 5, v186
    v_add_u32 v186, s71, v186
    v_lshlrev_b32 v187, 2, v182
    v_lshl_add_u32 v187, v184, 6, v187
    v_add_u32 v187, s72, v187
    v_lshl_add_u32 v188, v186, 10, v187
    v_add_u32 v189, 4096, v188
    v_subrev_u32 v190, 3072, v188
    v_lshlrev_b32 v191, 2, v187
    s_mov_b32 s38, 0x200000
    s_mov_b32 s39, 0x00020000
    s_mov_b32 s42, 0x200000
    s_mov_b32 s43, 0x00020000
    s_lshl_b32 s73, s68, 6
    s_lshl_b32 s74, s69, 1
    s_add_u32 s73, s73, s74
    s_lshl_b32 s75, s73, 12
    v_lshlrev_b32 v3, 4, v0
    v_add_u32 v3, s75, v3
    v_add_u32 v4, 4096, v3
    s_waitcnt lgkmcnt(0)
    s_mov_b32 s36, s6
    s_mov_b32 s37, s7
    s_mov_b32 s40, s8
    s_mov_b32 s41, s9
    buffer_load_dword v64, v190, s[36:39], 0 offen offset:0
    buffer_load_dword v65, v190, s[36:39], 0 offen offset:1024
    buffer_load_dword v66, v190, s[36:39], 0 offen offset:2048
    buffer_load_dword v67, v188, s[36:39], 0 offen offset:0
    buffer_load_dword v68, v188, s[36:39], 0 offen offset:1024
    buffer_load_dword v69, v188, s[36:39], 0 offen offset:2048
    buffer_load_dword v70, v188, s[36:39], 0 offen offset:3072
    buffer_load_dword v71, v189, s[36:39], 0 offen offset:0
    buffer_load_dword v72, v189, s[36:39], 0 offen offset:1024
    buffer_load_dword v73, v189, s[36:39], 0 offen offset:2048
    buffer_load_dword v74, v189, s[36:39], 0 offen offset:3072
    s_mov_b32 s44, s10
    s_mov_b32 s45, s11
    s_mov_b32 s46, 0x1000
    s_mov_b32 s47, 0x00020000
    s_mov_b32 s28, s26
    s_mov_b32 s29, s27
    s_mov_b32 s30, 0x1400000
    s_mov_b32 s31, 0x00020000
    buffer_load_dwordx4 v[92:95], v191, s[44:47], 0 offen
    s_mov_b32 s76, 4718592
    buffer_load_dword v200, off, s[28:31], s76
    buffer_load_dword v75, v188, s[40:43], 0 offen offset:0
    buffer_load_dword v76, v188, s[40:43], 0 offen offset:1024
    buffer_load_dword v77, v188, s[40:43], 0 offen offset:2048
    buffer_load_dword v78, v188, s[40:43], 0 offen offset:3072
    buffer_load_dword v79, v189, s[40:43], 0 offen offset:0
    buffer_load_dword v80, v189, s[40:43], 0 offen offset:1024
    buffer_load_dword v81, v189, s[40:43], 0 offen offset:2048
    buffer_load_dword v82, v189, s[40:43], 0 offen offset:3072
    s_mov_b32 s32, s4
    s_mov_b32 s33, s5
    s_mov_b32 s34, 0x200000
    s_mov_b32 s35, 0x00020000
    buffer_load_dword v83, v188, s[32:35], 0 offen offset:0
    buffer_load_dword v84, v188, s[32:35], 0 offen offset:1024
    buffer_load_dword v85, v188, s[32:35], 0 offen offset:2048
    buffer_load_dword v86, v188, s[32:35], 0 offen offset:3072
    buffer_load_dword v87, v189, s[32:35], 0 offen offset:0
    buffer_load_dword v88, v189, s[32:35], 0 offen offset:1024
    buffer_load_dword v89, v189, s[32:35], 0 offen offset:2048
    buffer_load_dword v90, v189, s[32:35], 0 offen offset:3072
    v_lshrrev_b32 v192, 5, v0
    s_lshl_b32 s76, s2, 3
    v_add_u32 v192, s76, v192
    v_and_b32 v193, 31, v0
    v_lshlrev_b32 v194, 4, v193
    v_lshl_add_u32 v194, v192, 10, v194
    buffer_load_dwordx4 v[96:99], v194, s[32:35], 0 offen
    buffer_load_dwordx4 v[100:103], v194, s[32:35], 0 offen offset:512
    s_mov_b32 s48, s12
    s_mov_b32 s49, s13
    s_mov_b32 s50, 0x200000
    s_mov_b32 s51, 0x00020000
    buffer_load_dwordx4 v[16:19], v3, s[48:51], 0 offen
    buffer_load_dwordx2 v[20:21], v3, s[48:51], 0 offen offset:16
    buffer_load_dwordx4 v[28:31], v4, s[48:51], 0 offen
    buffer_load_dwordx2 v[32:33], v4, s[48:51], 0 offen offset:16
    v_and_b32 v1, 63, v0
    v_lshrrev_b32 v2, 6, v0
    v_bfe_u32 v5, v1, 2, 1
    v_lshlrev_b32 v5, 12, v5
    v_readfirstlane_b32 s70, v2
    v_add_u32 v5, s75, v5
    buffer_load_dwordx2 v[48:49], v5, s[48:51], 0 offen
    s_lshl_b32 s3, s68, 12
    s_add_u32 s3, s3, 4784128
    v_and_b32 v6, 15, v1
    v_lshlrev_b32 v6, 7, v6
    buffer_load_dword v208, v6, s[28:31], s3 offen sc1
    s_mov_b32 s52, s14
    s_mov_b32 s53, s15
    s_mov_b32 s54, 0x400
    s_mov_b32 s55, 0x00020000
    s_lshr_b32 s77, s70, 1
    s_add_u32 s77, s77, s73
    s_lshl_b32 s77, s77, 1
    buffer_load_ushort v50, off, s[52:55], s77
    s_mov_b32 s56, s18
    s_mov_b32 s57, s19
    s_mov_b32 s58, 0x1c0000
    s_mov_b32 s59, 0x00020000
    s_mov_b32 s60, s20
    s_mov_b32 s61, s21
    s_mov_b32 s62, 0x1c0000
    s_mov_b32 s63, 0x00020000
    s_mov_b32 s64, s22
    s_mov_b32 s65, s23
    s_mov_b32 s66, 0x200000
    s_mov_b32 s67, 0x00020000
    s_getreg_b32 s74, hwreg(HW_REG_XCC_ID, 0, 4)
    s_mov_b32 s4, s70
    s_mov_b32 s5, s68
    s_mov_b32 s6, s69
    s_lshr_b32 s8, s70, 1
    s_and_b32 s9, s70, 1
    s_add_u32 s10, s73, s8
    s_lshl_b32 s11, s68, 1
    s_and_b32 s76, s69, 1
    s_add_u32 s11, s11, s76
    s_lshr_b32 s12, s69, 1
    s_lshl_b32 s13, s12, 2
    s_add_u32 s13, s13, s70
    s_lshl_b32 s14, s68, 1
    s_bfe_u32 s76, s69, 0x10001
    s_add_u32 s14, s14, s76
    s_lshr_b32 s15, s69, 2
    s_lshl_b32 s16, s15, 1
    s_add_u32 s16, s16, s8
    s_lshl_b32 s17, s14, 2
    s_and_b32 s76, s69, 1
    s_add_u32 s17, s17, s76
    s_mov_b32 s26, 0
    s_mul_i32 s18, s4, 458752
    s_add_u32 s22, s18, 458752
    s_min_u32 s23, s15, 6
    s_lshl_b32 s76, s23, 16
    s_add_u32 s18, s18, s76
    v_lshrrev_b32 v5, 3, v1
    v_and_b32 v6, 7, v1
    v_bfe_u32 v7, v1, 4, 1
    v_lshlrev_b32 v7, 2, v7
    v_xor_b32 v6, v6, v7
    v_lshlrev_b32 v2, 4, v6
    v_lshl_add_u32 v2, v5, 10, v2
    s_lshl_b32 s76, s15, 7
    v_add_u32 v2, s76, v2
    v_lshlrev_b32 v195, 11, v187
    v_lshlrev_b32 v196, 1, v186
    v_sub_u32 v197, v195, v196
    v_add_u32 v197, 4080, v197
    v_add_u32 v198, v195, v196
    v_add_u32 v198, 2097152, v198
    s_mul_i32 s19, s4, 20480
    s_add_u32 s19, s19, 75264
    v_bfe_u32 v5, v1, 2, 2
    v_and_b32 v6, 3, v1
    v_bfe_u32 v7, v1, 4, 1
    v_lshrrev_b32 v8, 5, v1
    v_lshlrev_b32 v9, 2, v8
    v_add_u32 v9, v9, v5
    v_lshlrev_b32 v9, 7, v9
    v_lshl_add_u32 v9, v7, 5, v9
    v_lshl_add_u32 v9, v6, 3, v9
    v_lshrrev_b32 v10, 1, v5
    v_xor_b32 v10, s8, v10
    v_lshl_add_u32 v3, v10, 6, v9
    v_xor_b32 v4, 64, v3
    v_lshlrev_b32 v51, 4, v0
    v_add_u32 v51, 32, v51
    v_mov_b32 v52, 0
    v_mov_b32 v53, 0
    v_mov_b32 v54, 0
    v_mov_b32 v55, 0
    v_lshrrev_b32 v5, 5, v1
    v_mul_u32_u24 v5, 4608, v5
    v_and_b32 v6, 31, v1
    v_lshl_add_u32 v5, v6, 4, v5
    v_add_u32 v5, 37376, v5
    ds_write_b128 v5, v[52:55]
    s_mov_b32 s76, 4096
    s_mov_b32 s77, 0x05040100
    s_mov_b32 s78, 0x07060302
    s_waitcnt vmcnt(25)
    v_readfirstlane_b32 s7, v200
    s_lshl_b32 s79, s6, 2
    s_add_u32 s79, s79, s3
    v_lshlrev_b32 v142, 16, v92
    v_lshlrev_b32 v143, 16, v94
    s_add_u32 s7, s7, 1
    s_lshl_b32 s27, s7, 4
    s_or_b32 s27, s27, s74
    v_mov_b32 v5, s27
    s_mov_b64 exec, 1
    buffer_store_dword v5, off, s[28:31], s79
    s_mov_b64 exec, -1
    v_and_b32 v144, 0xffff0000, v92
    v_and_b32 v145, 0xffff0000, v94
    v_lshlrev_b32 v146, 16, v93
    v_lshlrev_b32 v147, 16, v95
    v_and_b32 v148, 0xffff0000, v93
    v_and_b32 v149, 0xffff0000, v95
    v_lshlrev_b32 v104, 16, v64
    v_and_b32 v105, 0xffff0000, v64
    v_lshlrev_b32 v106, 16, v65
    v_and_b32 v107, 0xffff0000, v65
    v_lshlrev_b32 v108, 16, v66
    v_and_b32 v109, 0xffff0000, v66
    v_lshlrev_b32 v110, 16, v67
    v_and_b32 v111, 0xffff0000, v67
    v_lshlrev_b32 v112, 16, v68
    v_and_b32 v113, 0xffff0000, v68
    v_lshlrev_b32 v114, 16, v69
    v_and_b32 v115, 0xffff0000, v69
    v_lshlrev_b32 v116, 16, v70
    v_and_b32 v117, 0xffff0000, v70
    v_lshlrev_b32 v118, 16, v71
    v_and_b32 v119, 0xffff0000, v71
    v_lshlrev_b32 v120, 16, v72
    v_and_b32 v121, 0xffff0000, v72
    v_lshlrev_b32 v122, 16, v73
    v_and_b32 v123, 0xffff0000, v73
    v_lshlrev_b32 v124, 16, v74
    v_and_b32 v125, 0xffff0000, v74
    v_pk_mul_f32 v[150:151], v[110:111], v[142:143]
    v_pk_mul_f32 v[152:153], v[112:113], v[142:143]
    v_pk_mul_f32 v[154:155], v[114:115], v[142:143]
    v_pk_mul_f32 v[156:157], v[116:117], v[142:143]
    v_pk_mul_f32 v[158:159], v[118:119], v[142:143]
    v_pk_mul_f32 v[160:161], v[120:121], v[142:143]
    v_pk_mul_f32 v[162:163], v[122:123], v[142:143]
    v_pk_mul_f32 v[164:165], v[124:125], v[142:143]
    v_pk_fma_f32 v[150:151], v[108:109], v[144:145], v[150:151]
    v_pk_fma_f32 v[152:153], v[110:111], v[144:145], v[152:153]
    v_pk_fma_f32 v[154:155], v[112:113], v[144:145], v[154:155]
    v_pk_fma_f32 v[156:157], v[114:115], v[144:145], v[156:157]
    v_pk_fma_f32 v[158:159], v[116:117], v[144:145], v[158:159]
    v_pk_fma_f32 v[160:161], v[118:119], v[144:145], v[160:161]
    v_pk_fma_f32 v[162:163], v[120:121], v[144:145], v[162:163]
    v_pk_fma_f32 v[164:165], v[122:123], v[144:145], v[164:165]
    v_pk_fma_f32 v[150:151], v[106:107], v[146:147], v[150:151]
    v_pk_fma_f32 v[152:153], v[108:109], v[146:147], v[152:153]
    v_pk_fma_f32 v[154:155], v[110:111], v[146:147], v[154:155]
    v_pk_fma_f32 v[156:157], v[112:113], v[146:147], v[156:157]
    v_pk_fma_f32 v[158:159], v[114:115], v[146:147], v[158:159]
    v_pk_fma_f32 v[160:161], v[116:117], v[146:147], v[160:161]
    v_pk_fma_f32 v[162:163], v[118:119], v[146:147], v[162:163]
    v_pk_fma_f32 v[164:165], v[120:121], v[146:147], v[164:165]
    v_pk_fma_f32 v[150:151], v[104:105], v[148:149], v[150:151]
    v_pk_fma_f32 v[152:153], v[106:107], v[148:149], v[152:153]
    v_pk_fma_f32 v[154:155], v[108:109], v[148:149], v[154:155]
    v_pk_fma_f32 v[156:157], v[110:111], v[148:149], v[156:157]
    v_pk_fma_f32 v[158:159], v[112:113], v[148:149], v[158:159]
    v_pk_fma_f32 v[160:161], v[114:115], v[148:149], v[160:161]
    v_pk_fma_f32 v[162:163], v[116:117], v[148:149], v[162:163]
    v_pk_fma_f32 v[164:165], v[118:119], v[148:149], v[164:165]
    s_waitcnt vmcnt(18)
    v_lshlrev_b32 v126, 16, v75
    v_and_b32 v127, 0xffff0000, v75
    v_lshlrev_b32 v128, 16, v76
    v_and_b32 v129, 0xffff0000, v76
    v_lshlrev_b32 v130, 16, v77
    v_and_b32 v131, 0xffff0000, v77
    v_lshlrev_b32 v132, 16, v78
    v_and_b32 v133, 0xffff0000, v78
    v_lshlrev_b32 v134, 16, v79
    v_and_b32 v135, 0xffff0000, v79
    v_lshlrev_b32 v136, 16, v80
    v_and_b32 v137, 0xffff0000, v80
    v_lshlrev_b32 v138, 16, v81
    v_and_b32 v139, 0xffff0000, v81
    v_lshlrev_b32 v140, 16, v82
    v_and_b32 v141, 0xffff0000, v82
    v_pk_mul_f32 v[150:151], v[150:151], v[126:127]
    v_pk_mul_f32 v[152:153], v[152:153], v[128:129]
    v_pk_mul_f32 v[154:155], v[154:155], v[130:131]
    v_pk_mul_f32 v[156:157], v[156:157], v[132:133]
    v_pk_mul_f32 v[158:159], v[158:159], v[134:135]
    v_pk_mul_f32 v[160:161], v[160:161], v[136:137]
    v_pk_mul_f32 v[162:163], v[162:163], v[138:139]
    v_pk_mul_f32 v[164:165], v[164:165], v[140:141]
    v_cvt_pk_bf16_f32 v166, v164, v162
    v_cvt_pk_bf16_f32 v170, v165, v163
    v_cvt_pk_bf16_f32 v167, v160, v158
    v_cvt_pk_bf16_f32 v171, v161, v159
    v_cvt_pk_bf16_f32 v168, v156, v154
    v_cvt_pk_bf16_f32 v172, v157, v155
    v_cvt_pk_bf16_f32 v169, v152, v150
    v_cvt_pk_bf16_f32 v173, v153, v151
    buffer_store_dwordx4 v[166:169], v197, s[28:31], 0 offen sc1
    buffer_store_dwordx4 v[170:173], v197, s[28:31], s76 offen sc1
    s_waitcnt vmcnt(12)
    v_perm_b32 v174, v84, v83, s77
    v_perm_b32 v178, v84, v83, s78
    v_perm_b32 v175, v86, v85, s77
    v_perm_b32 v179, v86, v85, s78
    v_perm_b32 v176, v88, v87, s77
    v_perm_b32 v180, v88, v87, s78
    v_perm_b32 v177, v90, v89, s77
    v_perm_b32 v181, v90, v89, s78
    buffer_store_dwordx4 v[174:177], v198, s[28:31], 0 offen sc1
    buffer_store_dwordx4 v[178:181], v198, s[28:31], s76 offen sc1
    s_waitcnt vmcnt(12)
    v_mov_b32 v104, 0
    v_mov_b32 v105, 0
    v_mov_b32 v106, 0
    v_mov_b32 v107, 0
    v_mov_b32 v110, 0x3f803f80
    v_dot2c_f32_bf16 v104, v96, v110
    v_dot2c_f32_bf16 v105, v96, v96
    v_dot2c_f32_bf16 v106, v97, v110
    v_dot2c_f32_bf16 v107, v97, v97
    v_dot2c_f32_bf16 v104, v98, v110
    v_dot2c_f32_bf16 v105, v98, v98
    v_dot2c_f32_bf16 v106, v99, v110
    v_dot2c_f32_bf16 v107, v99, v99
    v_dot2c_f32_bf16 v104, v100, v110
    v_dot2c_f32_bf16 v105, v100, v100
    v_dot2c_f32_bf16 v106, v101, v110
    v_dot2c_f32_bf16 v107, v101, v101
    v_dot2c_f32_bf16 v104, v102, v110
    v_dot2c_f32_bf16 v105, v102, v102
    v_dot2c_f32_bf16 v106, v103, v110
    v_dot2c_f32_bf16 v107, v103, v103
    s_nop 1
    v_add_f32 v104, v104, v106
    v_add_f32 v105, v105, v107
    s_nop 0
    v_add_f32_dpp v104, v104, v104 quad_perm:[1,0,3,2] row_mask:0xf bank_mask:0xf
    v_add_f32_dpp v105, v105, v105 quad_perm:[1,0,3,2] row_mask:0xf bank_mask:0xf
    s_nop 0
    v_add_f32_dpp v104, v104, v104 quad_perm:[2,3,0,1] row_mask:0xf bank_mask:0xf
    v_add_f32_dpp v105, v105, v105 quad_perm:[2,3,0,1] row_mask:0xf bank_mask:0xf
    s_nop 0
    v_add_f32_dpp v104, v104, v104 row_half_mirror row_mask:0xf bank_mask:0xf
    v_add_f32_dpp v105, v105, v105 row_half_mirror row_mask:0xf bank_mask:0xf
    s_nop 0
    v_add_f32_dpp v104, v104, v104 row_mirror row_mask:0xf bank_mask:0xf
    v_add_f32_dpp v105, v105, v105 row_mirror row_mask:0xf bank_mask:0xf
    v_mov_b32 v107, v104
    v_mov_b32 v108, v105
    s_nop 0
    v_permlane16_swap_b32 v104, v107
    v_permlane16_swap_b32 v105, v108
    v_add_f32 v104, v104, v107
    v_add_f32 v105, v105, v108
    v_mul_f32 v104, 0x3b000000, v104
    v_mul_f32 v105, 0x3b000000, v105
    v_fma_f32 v105, -v104, v104, v105
    v_max_f32 v105, 0, v105
    v_cvt_pk_bf16_f32 v108, v105, v105
    v_lshlrev_b32 v105, 16, v108
    v_add_f32 v105, 0x3727c5ac, v105
    v_cvt_pk_bf16_f32 v108, v105, v105
    v_lshlrev_b32 v105, 16, v108
    v_sqrt_f32 v105, v105
    s_nop 0
    v_cvt_pk_bf16_f32 v108, v104, v105
    v_mov_b32 v109, s7
    v_lshlrev_b32 v107, 3, v192
    s_mov_b32 s82, 4194304
    s_mov_b32 exec_lo, 1
    s_mov_b32 exec_hi, 1
    buffer_store_dwordx2 v[108:109], v107, s[28:31], s82 offen sc1
    s_mov_b64 exec, -1
    v_and_b32 v201, 31, v1
    v_lshlrev_b32 v201, 2, v201
    buffer_load_dword v202, v201, s[28:31], s3 offen sc1
    s_mul_i32 s79, s2, 7168
    v_min_u32 v204, 55, v1
    v_lshlrev_b32 v204, 7, v204
    s_cmp_eq_u32 s4, 1
    s_cbranch_scc1 T11
    s_cmp_eq_u32 s4, 2
    s_cbranch_scc0 TD2
    buffer_load_dword v205, v201, s[28:31], s3 offen sc1
    s_branch TD2
T11:
    buffer_load_dword v205, v204, s[60:63], s79 offen sc1
TD2:
    s_sub_u32 s97, s4, 1
    s_cmp_lt_u32 s97, 2
    s_cbranch_scc0 WR3
    s_waitcnt vmcnt(8)
    s_branch WR4
WR3:
    s_waitcnt vmcnt(7)
WR4:
    v_alignbit_b32 v40, v17, v16, 16
    v_alignbit_b32 v41, v18, v17, 16
    v_alignbit_b32 v42, v19, v18, 16
    v_alignbit_b32 v43, v20, v19, 16
    v_alignbit_b32 v44, v18, v17, 16
    v_alignbit_b32 v45, v19, v18, 16
    v_alignbit_b32 v46, v20, v19, 16
    v_alignbit_b32 v47, v21, v20, 16
    v_mov_b32 v24, v17
    v_mov_b32 v25, v18
    v_mov_b32 v26, v19
    v_mov_b32 v27, v20
    ds_write_b128 v51, v[40:43] offset:0
    ds_write_b128 v51, v[44:47] offset:8320
    ds_write_b128 v51, v[18:21] offset:12480
    ds_write_b128 v51, v[24:27] offset:4160
    v_alignbit_b32 v56, v29, v28, 16
    v_alignbit_b32 v57, v30, v29, 16
    v_alignbit_b32 v58, v31, v30, 16
    v_alignbit_b32 v59, v32, v31, 16
    v_alignbit_b32 v60, v30, v29, 16
    v_alignbit_b32 v61, v31, v30, 16
    v_alignbit_b32 v62, v32, v31, 16
    v_alignbit_b32 v63, v33, v32, 16
    v_mov_b32 v36, v29
    v_mov_b32 v37, v30
    v_mov_b32 v38, v31
    v_mov_b32 v39, v32
    ds_write_b128 v51, v[56:59] offset:16640
    ds_write_b128 v51, v[60:63] offset:24960
    ds_write_b128 v51, v[30:33] offset:29120
    ds_write_b128 v51, v[36:39] offset:20800
    v_and_b32 v6, 3, v1
    v_sub_u32 v7, 3, v6
    v_lshlrev_b32 v7, 4, v7
    v_lshlrev_b64 v[54:55], v7, v[48:49]
    v_bfe_u32 v7, v1, 2, 1
    v_mul_u32_u24 v7, 16640, v7
    v_mul_u32_u24 v6, 4160, v6
    v_add3_u32 v6, v6, v7, 0
    v_mov_b32 v8, 0
    v_mov_b32 v9, 0
    v_mov_b32 v10, 0
    v_mov_b32 v11, 0
    s_mov_b64 exec, 0xff
    ds_write_b128 v6, v[8:11]
    ds_write_b128 v6, v[52:55] offset:16
    s_mov_b64 exec, -1
    v_lshlrev_b32 v15, 16, v50
    s_mul_i32 s79, s8, 4608
    v_and_b32 v11, 15, v1
    v_lshrrev_b32 v12, 4, v1
    v_lshlrev_b32 v13, 4, v11
    v_lshl_add_u32 v13, v12, 2, v13
    s_lshl_b32 s80, s9, 10
    v_add_u32 v13, s80, v13
    v_and_b32 v6, 3, v11
    v_mul_u32_u24 v6, 4160, v6
    v_lshrrev_b32 v7, 2, v11
    v_lshl_add_u32 v6, v7, 3, v6
    v_lshl_add_u32 v6, v12, 4, v6
    s_mul_i32 s83, s8, 16640
    s_lshl_b32 s84, s9, 6
    s_add_u32 s83, s83, s84
    s_add_u32 s83, s83, 0
    v_add_u32 v6, s83, v6
    v_lshlrev_b32 v7, 4, v12
    v_lshlrev_b32 v8, 5, v11
    v_sub_u32 v7, v7, v8
    s_add_u32 s83, s79, s84
    s_add_u32 s83, s83, 33760
    v_add_u32 v7, s83, v7
    v_lshlrev_b32 v14, 1, v13
    s_lshl_b32 s85, s10, 12
    s_add_u32 s85, s85, 2097152
    s_add_u32 s80, s3, 128
    s_lshl_b32 s81, s6, 2
    s_add_u32 s81, s81, s80
    s_sub_u32 s97, s4, 1
    s_cmp_lt_u32 s97, 2
    s_cbranch_scc0 WR5
    s_waitcnt vmcnt(1)
    s_branch WR6
WR5:
    s_waitcnt vmcnt(0)
WR6:
    v_cmp_ne_u32 vcc, s27, v202
    s_nop 0
    s_cmp_eq_u64 vcc, 0
    s_cselect_b32 s26, 1, 0
    s_waitcnt lgkmcnt(0)
    s_barrier
    s_cmp_eq_u32 s4, 0
    s_cbranch_scc1 W07
    s_branch AJ8
W07:
    v_mov_b32 v8, s7
    s_mov_b64 exec, 1
    s_cmp_eq_u32 s26, 0
    s_cbranch_scc1 FS9
    buffer_store_dword v8, off, s[28:31], s81
    s_branch FS10
FS9:
    buffer_store_dword v8, off, s[28:31], s81 sc1
FS10:
    s_mov_b64 exec, -1
    v_and_b32 v5, 31, v1
    v_lshlrev_b32 v5, 2, v5
    v_add_u32 v5, s80, v5
    s_mov_b32 s96, 0
POLL11:
    buffer_load_dword v8, v5, s[28:31], 0 offen sc1
    s_waitcnt vmcnt(0)
    v_cmp_ne_u32 vcc, s7, v8
    s_cbranch_vccz PDONE12
    s_add_u32 s96, s96, 1
    s_cmp_lt_u32 s96, 50000
    s_cbranch_scc1 POLL11
PDONE12:
    s_lshl_b32 s83, s10, 12
    s_add_u32 s83, s83, 0
    s_mov_b32 m0, 33280
    v_lshlrev_b32 v5, 4, v1
    s_add_u32 s84, s83, 4096
    buffer_load_dwordx4 v5, s[28:31], s83 offen sc1 lds
    buffer_load_dwordx4 v5, s[28:31], s83 offen offset:1024 sc1 lds
    buffer_load_dwordx4 v5, s[28:31], s83 offen offset:2048 sc1 lds
    buffer_load_dwordx4 v5, s[28:31], s83 offen offset:3072 sc1 lds
    s_mov_b32 m0, 37888
    s_nop 0
    buffer_load_dwordx4 v5, s[28:31], s84 offen sc1 lds
    buffer_load_dwordx4 v5, s[28:31], s84 offen offset:1024 sc1 lds
    buffer_load_dwordx4 v5, s[28:31], s84 offen offset:2048 sc1 lds
    buffer_load_dwordx4 v5, s[28:31], s84 offen offset:3072 sc1 lds
    v_min_u32 v5, 63, v1
    s_lshl_b32 s97, s23, 6
    s_add_u32 s97, s97, 0
    v_add_u32 v5, s97, v5
    v_subrev_u32 v8, 448, v5
    v_min_u32 v5, v5, v8
    v_lshlrev_b32 v5, 10, v5
    s_and_b32 s97, s6, 3
    s_mul_i32 s97, s97, 458752
    s_lshl_b32 s94, s15, 7
    s_add_u32 s97, s97, s94
    buffer_load_dword v252, v5, s[60:63], s97 offen sc1
    v_min_u32 v5, 63, v1
    s_lshl_b32 s97, s23, 6
    s_add_u32 s97, s97, 64
    v_add_u32 v5, s97, v5
    v_subrev_u32 v8, 448, v5
    v_min_u32 v5, v5, v8
    v_lshlrev_b32 v5, 10, v5
    s_and_b32 s97, s6, 3
    s_mul_i32 s97, s97, 458752
    s_lshl_b32 s94, s15, 7
    s_add_u32 s97, s97, s94
    buffer_load_dword v252, v5, s[60:63], s97 offen sc1
    v_min_u32 v5, 31, v1
    s_lshl_b32 s97, s23, 6
    s_add_u32 s97, s97, 128
    v_add_u32 v5, s97, v5
    v_subrev_u32 v8, 448, v5
    v_min_u32 v5, v5, v8
    v_lshlrev_b32 v5, 10, v5
    s_and_b32 s97, s6, 3
    s_mul_i32 s97, s97, 458752
    s_lshl_b32 s94, s15, 7
    s_add_u32 s97, s97, s94
    buffer_load_dword v252, v5, s[60:63], s97 offen sc1
AJ8:
    ds_read_b64 v[96:97], v6 offset:0
    ds_read_b64 v[98:99], v6 offset:8
    ds_read_b64 v[100:101], v6 offset:512
    ds_read_b64 v[102:103], v6 offset:520
    ds_read_b64 v[104:105], v6 offset:1024
    ds_read_b64 v[106:107], v6 offset:1032
    ds_read_b64 v[108:109], v6 offset:1536
    ds_read_b64 v[110:111], v6 offset:1544
    ds_read_b64 v[112:113], v6 offset:2048
    ds_read_b64 v[114:115], v6 offset:2056
    ds_read_b64 v[116:117], v6 offset:2560
    ds_read_b64 v[118:119], v6 offset:2568
    ds_read_b64 v[120:121], v6 offset:3072
    ds_read_b64 v[122:123], v6 offset:3080
    ds_read_b64 v[124:125], v6 offset:3584
    ds_read_b64 v[126:127], v6 offset:3592
    s_cmp_lg_u32 s4, 0
    s_cbranch_scc1 NW13
    s_waitcnt vmcnt(3)
NW13:
    s_barrier
    ds_read_b128 v[160:163], v7 offset:3584
    ds_read_b128 v[164:167], v7 offset:3072
    ds_read_b128 v[168:171], v7 offset:2560
    ds_read_b128 v[172:175], v7 offset:2048
    ds_read_b128 v[176:179], v7 offset:1536
    ds_read_b128 v[180:183], v7 offset:1024
    ds_read_b128 v[184:187], v7 offset:512
    ds_read_b128 v[188:191], v7 offset:0
    s_waitcnt lgkmcnt(0)
    s_lshl_b32 s83, s4, 12
    s_add_u32 s84, s83, 4194304
    s_add_u32 s83, s83, 42496
    s_mov_b32 m0, s83
    v_lshlrev_b32 v5, 4, v1
    v_mfma_f32_16x16x32_bf16 v[64:67], v[96:99], v[160:163], 0
    v_mfma_f32_16x16x32_bf16 v[68:71], v[96:99], v[164:167], 0
    buffer_load_dwordx2 v[224:225], v14, s[28:31], s85 offen offset:0 sc1
    v_mfma_f32_16x16x32_bf16 v[72:75], v[96:99], v[168:171], 0
    ds_read_b64 v[128:129], v6 offset:128
    v_mfma_f32_16x16x32_bf16 v[76:79], v[96:99], v[172:175], 0
    ds_read_b64 v[130:131], v6 offset:136
    buffer_load_dwordx2 v[226:227], v14, s[28:31], s85 offen offset:512 sc1
    v_mfma_f32_16x16x32_bf16 v[80:83], v[96:99], v[176:179], 0
    ds_read_b128 v[192:195], v7 offset:3712
    v_mfma_f32_16x16x32_bf16 v[84:87], v[96:99], v[180:183], 0
    ds_read_b64 v[132:133], v6 offset:640
    buffer_load_dwordx2 v[228:229], v14, s[28:31], s85 offen offset:1024 sc1
    v_mfma_f32_16x16x32_bf16 v[88:91], v[96:99], v[184:187], 0
    ds_read_b64 v[134:135], v6 offset:648
    v_mfma_f32_16x16x32_bf16 v[92:95], v[96:99], v[188:191], 0
    ds_read_b128 v[196:199], v7 offset:3200
    buffer_load_dwordx2 v[230:231], v14, s[28:31], s85 offen offset:1536 sc1
    v_mfma_f32_16x16x32_bf16 v[68:71], v[100:103], v[160:163], v[68:71]
    ds_read_b64 v[136:137], v6 offset:1152
    v_mfma_f32_16x16x32_bf16 v[72:75], v[100:103], v[164:167], v[72:75]
    ds_read_b64 v[138:139], v6 offset:1160
    v_mfma_f32_16x16x32_bf16 v[76:79], v[100:103], v[168:171], v[76:79]
    ds_read_b128 v[200:203], v7 offset:2688
    v_mfma_f32_16x16x32_bf16 v[80:83], v[100:103], v[172:175], v[80:83]
    ds_read_b64 v[140:141], v6 offset:1664
    v_mfma_f32_16x16x32_bf16 v[84:87], v[100:103], v[176:179], v[84:87]
    ds_read_b64 v[142:143], v6 offset:1672
    v_mfma_f32_16x16x32_bf16 v[88:91], v[100:103], v[180:183], v[88:91]
    ds_read_b128 v[204:207], v7 offset:2176
    v_mfma_f32_16x16x32_bf16 v[92:95], v[100:103], v[184:187], v[92:95]
    ds_read_b64 v[144:145], v6 offset:2176
    v_mfma_f32_16x16x32_bf16 v[72:75], v[104:107], v[160:163], v[72:75]
    ds_read_b64 v[146:147], v6 offset:2184
    v_mfma_f32_16x16x32_bf16 v[76:79], v[104:107], v[164:167], v[76:79]
    ds_read_b128 v[208:211], v7 offset:1664
    v_mfma_f32_16x16x32_bf16 v[80:83], v[104:107], v[168:171], v[80:83]
    ds_read_b64 v[148:149], v6 offset:2688
    v_mfma_f32_16x16x32_bf16 v[84:87], v[104:107], v[172:175], v[84:87]
    ds_read_b64 v[150:151], v6 offset:2696
    v_mfma_f32_16x16x32_bf16 v[88:91], v[104:107], v[176:179], v[88:91]
    ds_read_b128 v[212:215], v7 offset:1152
    v_mfma_f32_16x16x32_bf16 v[92:95], v[104:107], v[180:183], v[92:95]
    ds_read_b64 v[152:153], v6 offset:3200
    buffer_load_dwordx4 v5, s[28:31], s84 offen offset:0 sc1 lds
    v_mfma_f32_16x16x32_bf16 v[76:79], v[108:111], v[160:163], v[76:79]
    ds_read_b64 v[154:155], v6 offset:3208
    v_mfma_f32_16x16x32_bf16 v[80:83], v[108:111], v[164:167], v[80:83]
    ds_read_b128 v[216:219], v7 offset:640
    v_mfma_f32_16x16x32_bf16 v[84:87], v[108:111], v[168:171], v[84:87]
    ds_read_b64 v[156:157], v6 offset:3712
    buffer_load_dwordx4 v5, s[28:31], s84 offen offset:1024 sc1 lds
    v_mfma_f32_16x16x32_bf16 v[88:91], v[108:111], v[172:175], v[88:91]
    ds_read_b64 v[158:159], v6 offset:3720
    v_mfma_f32_16x16x32_bf16 v[92:95], v[108:111], v[176:179], v[92:95]
    ds_read_b128 v[220:223], v7 offset:128
    v_mfma_f32_16x16x32_bf16 v[80:83], v[112:115], v[160:163], v[80:83]
    buffer_load_dwordx4 v5, s[28:31], s84 offen offset:2048 sc1 lds
    v_mfma_f32_16x16x32_bf16 v[84:87], v[112:115], v[164:167], v[84:87]
    v_mfma_f32_16x16x32_bf16 v[88:91], v[112:115], v[168:171], v[88:91]
    v_mfma_f32_16x16x32_bf16 v[92:95], v[112:115], v[172:175], v[92:95]
    buffer_load_dwordx4 v5, s[28:31], s84 offen offset:3072 sc1 lds
    v_mfma_f32_16x16x32_bf16 v[84:87], v[116:119], v[160:163], v[84:87]
    v_mfma_f32_16x16x32_bf16 v[88:91], v[116:119], v[164:167], v[88:91]
    v_mfma_f32_16x16x32_bf16 v[92:95], v[116:119], v[168:171], v[92:95]
    v_mfma_f32_16x16x32_bf16 v[88:91], v[120:123], v[160:163], v[88:91]
    v_and_b32 v250, 31, v1
    v_lshlrev_b32 v250, 2, v250
    buffer_load_dword v251, v250, s[28:31], s3 offen sc1
    v_mfma_f32_16x16x32_bf16 v[92:95], v[120:123], v[164:167], v[92:95]
    v_mfma_f32_16x16x32_bf16 v[92:95], v[124:127], v[160:163], v[92:95]
    s_waitcnt lgkmcnt(0)
    v_mfma_f32_16x16x32_bf16 v[64:67], v[128:131], v[192:195], v[64:67]
    v_mfma_f32_16x16x32_bf16 v[68:71], v[128:131], v[196:199], v[68:71]
    v_mfma_f32_16x16x32_bf16 v[72:75], v[128:131], v[200:203], v[72:75]
    ds_read_b64 v[96:97], v6 offset:256
    s_mov_b32 m0, s19
    s_nop 0
    buffer_load_dwordx4 v2, s[60:63], s18 offen lds
    s_add_u32 s18, s18, 8192
    s_add_u32 m0, m0, 1024
    s_cmp_eq_u32 s18, s22
    s_cselect_b32 s97, 458752, 0
    s_sub_u32 s18, s18, s97
    v_mfma_f32_16x16x32_bf16 v[76:79], v[128:131], v[204:207], v[76:79]
    ds_read_b64 v[98:99], v6 offset:264
    v_mfma_f32_16x16x32_bf16 v[80:83], v[128:131], v[208:211], v[80:83]
    ds_read_b128 v[160:163], v7 offset:3840
    v_mfma_f32_16x16x32_bf16 v[84:87], v[128:131], v[212:215], v[84:87]
    ds_read_b64 v[100:101], v6 offset:768
    v_mfma_f32_16x16x32_bf16 v[88:91], v[128:131], v[216:219], v[88:91]
    ds_read_b64 v[102:103], v6 offset:776
    v_mfma_f32_16x16x32_bf16 v[92:95], v[128:131], v[220:223], v[92:95]
    ds_read_b128 v[164:167], v7 offset:3328
    buffer_load_dwordx4 v2, s[60:63], s18 offen lds
    s_add_u32 s18, s18, 8192
    s_add_u32 m0, m0, 1024
    s_cmp_eq_u32 s18, s22
    s_cselect_b32 s97, 458752, 0
    s_sub_u32 s18, s18, s97
    v_mfma_f32_16x16x32_bf16 v[68:71], v[132:135], v[192:195], v[68:71]
    ds_read_b64 v[104:105], v6 offset:1280
    v_mfma_f32_16x16x32_bf16 v[72:75], v[132:135], v[196:199], v[72:75]
    ds_read_b64 v[106:107], v6 offset:1288
    v_mfma_f32_16x16x32_bf16 v[76:79], v[132:135], v[200:203], v[76:79]
    ds_read_b128 v[168:171], v7 offset:2816
    v_mfma_f32_16x16x32_bf16 v[80:83], v[132:135], v[204:207], v[80:83]
    ds_read_b64 v[108:109], v6 offset:1792
    v_mfma_f32_16x16x32_bf16 v[84:87], v[132:135], v[208:211], v[84:87]
    ds_read_b64 v[110:111], v6 offset:1800
    buffer_load_dwordx4 v2, s[60:63], s18 offen lds
    s_add_u32 s18, s18, 8192
    s_add_u32 m0, m0, 1024
    s_cmp_eq_u32 s18, s22
    s_cselect_b32 s97, 458752, 0
    s_sub_u32 s18, s18, s97
    v_mfma_f32_16x16x32_bf16 v[88:91], v[132:135], v[212:215], v[88:91]
    ds_read_b128 v[172:175], v7 offset:2304
    v_mfma_f32_16x16x32_bf16 v[92:95], v[132:135], v[216:219], v[92:95]
    ds_read_b64 v[112:113], v6 offset:2304
    v_mfma_f32_16x16x32_bf16 v[72:75], v[136:139], v[192:195], v[72:75]
    ds_read_b64 v[114:115], v6 offset:2312
    v_mfma_f32_16x16x32_bf16 v[76:79], v[136:139], v[196:199], v[76:79]
    ds_read_b128 v[176:179], v7 offset:1792
    v_mfma_f32_16x16x32_bf16 v[80:83], v[136:139], v[200:203], v[80:83]
    ds_read_b64 v[116:117], v6 offset:2816
    buffer_load_dwordx4 v2, s[60:63], s18 offen lds
    s_add_u32 s18, s18, 8192
    s_add_u32 m0, m0, 1024
    s_cmp_eq_u32 s18, s22
    s_cselect_b32 s97, 458752, 0
    s_sub_u32 s18, s18, s97
    v_mfma_f32_16x16x32_bf16 v[84:87], v[136:139], v[204:207], v[84:87]
    ds_read_b64 v[118:119], v6 offset:2824
    v_mfma_f32_16x16x32_bf16 v[88:91], v[136:139], v[208:211], v[88:91]
    ds_read_b128 v[180:183], v7 offset:1280
    v_mfma_f32_16x16x32_bf16 v[92:95], v[136:139], v[212:215], v[92:95]
    ds_read_b64 v[120:121], v6 offset:3328
    v_mfma_f32_16x16x32_bf16 v[76:79], v[140:143], v[192:195], v[76:79]
    ds_read_b64 v[122:123], v6 offset:3336
    v_mfma_f32_16x16x32_bf16 v[80:83], v[140:143], v[196:199], v[80:83]
    ds_read_b128 v[184:187], v7 offset:768
    buffer_load_dwordx4 v2, s[60:63], s18 offen lds
    s_add_u32 s18, s18, 8192
    s_add_u32 m0, m0, 1024
    s_cmp_eq_u32 s18, s22
    s_cselect_b32 s97, 458752, 0
    s_sub_u32 s18, s18, s97
    v_mfma_f32_16x16x32_bf16 v[84:87], v[140:143], v[200:203], v[84:87]
    ds_read_b64 v[124:125], v6 offset:3840
    v_mfma_f32_16x16x32_bf16 v[88:91], v[140:143], v[204:207], v[88:91]
    ds_read_b64 v[126:127], v6 offset:3848
    v_mfma_f32_16x16x32_bf16 v[92:95], v[140:143], v[208:211], v[92:95]
    ds_read_b128 v[188:191], v7 offset:256
    v_mfma_f32_16x16x32_bf16 v[80:83], v[144:147], v[192:195], v[80:83]
    v_mfma_f32_16x16x32_bf16 v[84:87], v[144:147], v[196:199], v[84:87]
    buffer_load_dwordx4 v2, s[60:63], s18 offen lds
    s_add_u32 s18, s18, 8192
    s_add_u32 m0, m0, 1024
    s_cmp_eq_u32 s18, s22
    s_cselect_b32 s97, 458752, 0
    s_sub_u32 s18, s18, s97
    v_mfma_f32_16x16x32_bf16 v[88:91], v[144:147], v[200:203], v[88:91]
    v_mfma_f32_16x16x32_bf16 v[92:95], v[144:147], v[204:207], v[92:95]
    v_mfma_f32_16x16x32_bf16 v[84:87], v[148:151], v[192:195], v[84:87]
    v_mfma_f32_16x16x32_bf16 v[88:91], v[148:151], v[196:199], v[88:91]
    v_mfma_f32_16x16x32_bf16 v[92:95], v[148:151], v[200:203], v[92:95]
    buffer_load_dwordx4 v2, s[60:63], s18 offen lds
    s_add_u32 s18, s18, 8192
    s_add_u32 m0, m0, 1024
    s_cmp_eq_u32 s18, s22
    s_cselect_b32 s97, 458752, 0
    s_sub_u32 s18, s18, s97
    v_mfma_f32_16x16x32_bf16 v[88:91], v[152:155], v[192:195], v[88:91]
    v_mfma_f32_16x16x32_bf16 v[92:95], v[152:155], v[196:199], v[92:95]
    v_mfma_f32_16x16x32_bf16 v[92:95], v[156:159], v[192:195], v[92:95]
    s_waitcnt lgkmcnt(0)
    v_mfma_f32_16x16x32_bf16 v[64:67], v[96:99], v[160:163], v[64:67]
    v_mfma_f32_16x16x32_bf16 v[68:71], v[96:99], v[164:167], v[68:71]
    v_mfma_f32_16x16x32_bf16 v[72:75], v[96:99], v[168:171], v[72:75]
    ds_read_b64 v[128:129], v6 offset:384
    buffer_load_dwordx4 v2, s[60:63], s18 offen lds
    s_add_u32 s18, s18, 8192
    s_add_u32 m0, m0, 1024
    s_cmp_eq_u32 s18, s22
    s_cselect_b32 s97, 458752, 0
    s_sub_u32 s18, s18, s97
    v_mfma_f32_16x16x32_bf16 v[76:79], v[96:99], v[172:175], v[76:79]
    ds_read_b64 v[130:131], v6 offset:392
    v_mfma_f32_16x16x32_bf16 v[80:83], v[96:99], v[176:179], v[80:83]
    ds_read_b128 v[192:195], v7 offset:3968
    v_mfma_f32_16x16x32_bf16 v[84:87], v[96:99], v[180:183], v[84:87]
    ds_read_b64 v[132:133], v6 offset:896
    v_mfma_f32_16x16x32_bf16 v[88:91], v[96:99], v[184:187], v[88:91]
    ds_read_b64 v[134:135], v6 offset:904
    v_mfma_f32_16x16x32_bf16 v[92:95], v[96:99], v[188:191], v[92:95]
    ds_read_b128 v[196:199], v7 offset:3456
    buffer_load_dwordx4 v2, s[60:63], s18 offen lds
    s_add_u32 s18, s18, 8192
    s_add_u32 m0, m0, 1024
    s_cmp_eq_u32 s18, s22
    s_cselect_b32 s97, 458752, 0
    s_sub_u32 s18, s18, s97
    v_mfma_f32_16x16x32_bf16 v[68:71], v[100:103], v[160:163], v[68:71]
    ds_read_b64 v[136:137], v6 offset:1408
    v_mfma_f32_16x16x32_bf16 v[72:75], v[100:103], v[164:167], v[72:75]
    ds_read_b64 v[138:139], v6 offset:1416
    v_mfma_f32_16x16x32_bf16 v[76:79], v[100:103], v[168:171], v[76:79]
    ds_read_b128 v[200:203], v7 offset:2944
    v_mfma_f32_16x16x32_bf16 v[80:83], v[100:103], v[172:175], v[80:83]
    ds_read_b64 v[140:141], v6 offset:1920
    v_mfma_f32_16x16x32_bf16 v[84:87], v[100:103], v[176:179], v[84:87]
    ds_read_b64 v[142:143], v6 offset:1928
    buffer_load_dwordx4 v2, s[60:63], s18 offen lds
    s_add_u32 s18, s18, 8192
    s_add_u32 m0, m0, 1024
    s_cmp_eq_u32 s18, s22
    s_cselect_b32 s97, 458752, 0
    s_sub_u32 s18, s18, s97
    v_mfma_f32_16x16x32_bf16 v[88:91], v[100:103], v[180:183], v[88:91]
    ds_read_b128 v[204:207], v7 offset:2432
    v_mfma_f32_16x16x32_bf16 v[92:95], v[100:103], v[184:187], v[92:95]
    ds_read_b64 v[144:145], v6 offset:2432
    v_mfma_f32_16x16x32_bf16 v[72:75], v[104:107], v[160:163], v[72:75]
    ds_read_b64 v[146:147], v6 offset:2440
    v_mfma_f32_16x16x32_bf16 v[76:79], v[104:107], v[164:167], v[76:79]
    ds_read_b128 v[208:211], v7 offset:1920
    v_mfma_f32_16x16x32_bf16 v[80:83], v[104:107], v[168:171], v[80:83]
    ds_read_b64 v[148:149], v6 offset:2944
    buffer_load_dwordx4 v2, s[60:63], s18 offen lds
    s_add_u32 s18, s18, 8192
    s_add_u32 m0, m0, 1024
    s_cmp_eq_u32 s18, s22
    s_cselect_b32 s97, 458752, 0
    s_sub_u32 s18, s18, s97
    v_mfma_f32_16x16x32_bf16 v[84:87], v[104:107], v[172:175], v[84:87]
    ds_read_b64 v[150:151], v6 offset:2952
    v_mfma_f32_16x16x32_bf16 v[88:91], v[104:107], v[176:179], v[88:91]
    ds_read_b128 v[212:215], v7 offset:1408
    v_mfma_f32_16x16x32_bf16 v[92:95], v[104:107], v[180:183], v[92:95]
    ds_read_b64 v[152:153], v6 offset:3456
    v_mfma_f32_16x16x32_bf16 v[76:79], v[108:111], v[160:163], v[76:79]
    ds_read_b64 v[154:155], v6 offset:3464
    v_mfma_f32_16x16x32_bf16 v[80:83], v[108:111], v[164:167], v[80:83]
    ds_read_b128 v[216:219], v7 offset:896
    buffer_load_dwordx4 v2, s[60:63], s18 offen lds
    s_add_u32 s18, s18, 8192
    s_add_u32 m0, m0, 1024
    s_cmp_eq_u32 s18, s22
    s_cselect_b32 s97, 458752, 0
    s_sub_u32 s18, s18, s97
    v_mfma_f32_16x16x32_bf16 v[84:87], v[108:111], v[168:171], v[84:87]
    ds_read_b64 v[156:157], v6 offset:3968
    v_mfma_f32_16x16x32_bf16 v[88:91], v[108:111], v[172:175], v[88:91]
    ds_read_b64 v[158:159], v6 offset:3976
    v_mfma_f32_16x16x32_bf16 v[92:95], v[108:111], v[176:179], v[92:95]
    ds_read_b128 v[220:223], v7 offset:384
    v_mfma_f32_16x16x32_bf16 v[80:83], v[112:115], v[160:163], v[80:83]
    v_mfma_f32_16x16x32_bf16 v[84:87], v[112:115], v[164:167], v[84:87]
    buffer_load_dwordx4 v2, s[60:63], s18 offen lds
    s_add_u32 s18, s18, 8192
    s_add_u32 m0, m0, 1024
    s_cmp_eq_u32 s18, s22
    s_cselect_b32 s97, 458752, 0
    s_sub_u32 s18, s18, s97
    v_mfma_f32_16x16x32_bf16 v[88:91], v[112:115], v[168:171], v[88:91]
    v_mfma_f32_16x16x32_bf16 v[92:95], v[112:115], v[172:175], v[92:95]
    v_mfma_f32_16x16x32_bf16 v[84:87], v[116:119], v[160:163], v[84:87]
    v_mfma_f32_16x16x32_bf16 v[88:91], v[116:119], v[164:167], v[88:91]
    v_mfma_f32_16x16x32_bf16 v[92:95], v[116:119], v[168:171], v[92:95]
    buffer_load_dwordx4 v2, s[60:63], s18 offen lds
    s_add_u32 s18, s18, 8192
    s_add_u32 m0, m0, 1024
    s_cmp_eq_u32 s18, s22
    s_cselect_b32 s97, 458752, 0
    s_sub_u32 s18, s18, s97
    v_mfma_f32_16x16x32_bf16 v[88:91], v[120:123], v[160:163], v[88:91]
    v_mfma_f32_16x16x32_bf16 v[92:95], v[120:123], v[164:167], v[92:95]
    v_mfma_f32_16x16x32_bf16 v[92:95], v[124:127], v[160:163], v[92:95]
    s_mul_i32 s87, s2, 7168
    s_mul_i32 s88, s4, 1792
    s_add_u32 s87, s87, s88
    v_min_u32 v254, 13, v1
    v_lshlrev_b32 v254, 7, v254
    buffer_load_dword v253, v254, s[56:59], s87 offen sc1
    s_waitcnt lgkmcnt(0)
    s_waitcnt vmcnt(15)
    s_barrier
    v_cmp_ne_u32 vcc, s27, v251
    s_nop 0
    s_cmp_eq_u64 vcc, 0
    s_cselect_b32 s26, 1, 0
    v_lshlrev_b32 v5, 3, v13
    v_add_u32 v5, 42496, v5
    s_add_u32 s83, s79, 35832
    v_sub_u32 v10, s83, v14
    v_mfma_f32_16x16x32_bf16 v[64:67], v[128:131], v[192:195], v[64:67]
    ds_read_b128 v[16:19], v5 offset:0
    v_mfma_f32_16x16x32_bf16 v[68:71], v[128:131], v[196:199], v[68:71]
    ds_read_b128 v[20:23], v5 offset:16
    buffer_load_dwordx4 v2, s[60:63], s18 offen lds
    s_add_u32 s18, s18, 8192
    s_add_u32 m0, m0, 1024
    s_cmp_eq_u32 s18, s22
    s_cselect_b32 s97, 458752, 0
    s_sub_u32 s18, s18, s97
    v_mfma_f32_16x16x32_bf16 v[72:75], v[128:131], v[200:203], v[72:75]
    ds_read_b128 v[24:27], v5 offset:2048
    v_mfma_f32_16x16x32_bf16 v[76:79], v[128:131], v[204:207], v[76:79]
    ds_read_b128 v[28:31], v5 offset:2064
    v_mfma_f32_16x16x32_bf16 v[80:83], v[128:131], v[208:211], v[80:83]
    ds_read_b128 v[32:35], v5 offset:4096
    buffer_load_dwordx4 v2, s[60:63], s18 offen lds
    s_add_u32 s18, s18, 8192
    s_add_u32 m0, m0, 1024
    s_cmp_eq_u32 s18, s22
    s_cselect_b32 s97, 458752, 0
    s_sub_u32 s18, s18, s97
    v_mfma_f32_16x16x32_bf16 v[84:87], v[128:131], v[212:215], v[84:87]
    ds_read_b128 v[36:39], v5 offset:4112
    v_mfma_f32_16x16x32_bf16 v[88:91], v[128:131], v[216:219], v[88:91]
    ds_read_b128 v[40:43], v5 offset:6144
    v_mfma_f32_16x16x32_bf16 v[92:95], v[128:131], v[220:223], v[92:95]
    ds_read_b128 v[44:47], v5 offset:6160
    buffer_load_dwordx4 v2, s[60:63], s18 offen lds
    s_add_u32 s18, s18, 8192
    s_add_u32 m0, m0, 1024
    s_cmp_eq_u32 s18, s22
    s_cselect_b32 s97, 458752, 0
    s_sub_u32 s18, s18, s97
    v_mfma_f32_16x16x32_bf16 v[68:71], v[132:135], v[192:195], v[68:71]
    ds_read_b64 v[112:113], v10 offset:1536
    v_mfma_f32_16x16x32_bf16 v[72:75], v[132:135], v[196:199], v[72:75]
    ds_read_b64 v[114:115], v10 offset:1024
    v_mfma_f32_16x16x32_bf16 v[76:79], v[132:135], v[200:203], v[76:79]
    ds_read_b64 v[116:117], v10 offset:512
    buffer_load_dwordx4 v2, s[60:63], s18 offen lds
    s_add_u32 s18, s18, 8192
    s_add_u32 m0, m0, 1024
    s_cmp_eq_u32 s18, s22
    s_cselect_b32 s97, 458752, 0
    s_sub_u32 s18, s18, s97
    v_mfma_f32_16x16x32_bf16 v[80:83], v[132:135], v[204:207], v[80:83]
    ds_read_b64 v[118:119], v10 offset:0
    v_mfma_f32_16x16x32_bf16 v[84:87], v[132:135], v[208:211], v[84:87]
    v_mfma_f32_16x16x32_bf16 v[88:91], v[132:135], v[212:215], v[88:91]
    buffer_load_dwordx4 v2, s[60:63], s18 offen lds
    s_add_u32 s18, s18, 8192
    s_add_u32 m0, m0, 1024
    s_cmp_eq_u32 s18, s22
    s_cselect_b32 s97, 458752, 0
    s_sub_u32 s18, s18, s97
    v_mfma_f32_16x16x32_bf16 v[92:95], v[132:135], v[216:219], v[92:95]
    v_mfma_f32_16x16x32_bf16 v[72:75], v[136:139], v[192:195], v[72:75]
    v_mfma_f32_16x16x32_bf16 v[76:79], v[136:139], v[196:199], v[76:79]
    buffer_load_dwordx4 v2, s[60:63], s18 offen lds
    s_add_u32 s18, s18, 8192
    s_add_u32 m0, m0, 1024
    s_cmp_eq_u32 s18, s22
    s_cselect_b32 s97, 458752, 0
    s_sub_u32 s18, s18, s97
    v_mfma_f32_16x16x32_bf16 v[80:83], v[136:139], v[200:203], v[80:83]
    s_waitcnt lgkmcnt(0)
    s_mov_b32 s96, 0
XSRE15:
    v_min3_u32 v8, v17, v19, v21
    v_max3_u32 v9, v17, v19, v21
    v_min3_u32 v8, v8, v23, v25
    v_max3_u32 v9, v9, v23, v25
    v_min3_u32 v8, v8, v27, v29
    v_max3_u32 v9, v9, v27, v29
    v_min3_u32 v8, v8, v31, v33
    v_max3_u32 v9, v9, v31, v33
    v_min3_u32 v8, v8, v35, v37
    v_max3_u32 v9, v9, v35, v37
    v_min3_u32 v8, v8, v39, v41
    v_max3_u32 v9, v9, v39, v41
    v_min3_u32 v8, v8, v43, v45
    v_max3_u32 v9, v9, v43, v45
    v_min_u32 v8, v8, v47
    v_max_u32 v9, v9, v47
    v_xor_b32 v8, s7, v8
    v_xor_b32 v9, s7, v9
    v_or_b32 v8, v8, v9
    v_cmp_ne_u32 vcc, 0, v8
    s_cbranch_vccz XSOK14
    s_add_u32 s96, s96, 1
    s_cmp_ge_u32 s96, 50000
    s_cbranch_scc1 XSOK14
    v_lshlrev_b32 v5, 3, v13
    s_mov_b32 s87, 4194304
    s_mov_b32 s88, 4198400
    buffer_load_dwordx4 v[16:19], v5, s[28:31], s87 offen offset:0 sc1
    buffer_load_dwordx4 v[20:23], v5, s[28:31], s87 offen offset:16 sc1
    buffer_load_dwordx4 v[24:27], v5, s[28:31], s87 offen offset:2048 sc1
    buffer_load_dwordx4 v[28:31], v5, s[28:31], s87 offen offset:2064 sc1
    buffer_load_dwordx4 v[32:35], v5, s[28:31], s88 offen offset:0 sc1
    buffer_load_dwordx4 v[36:39], v5, s[28:31], s88 offen offset:16 sc1
    buffer_load_dwordx4 v[40:43], v5, s[28:31], s88 offen offset:2048 sc1
    buffer_load_dwordx4 v[44:47], v5, s[28:31], s88 offen offset:2064 sc1
    s_waitcnt vmcnt(0)
    s_branch XSRE15
XSOK14:
    v_and_b32 v232, 0xffff0000, v16
    v_lshlrev_b32 v48, 16, v16
    v_rcp_f32 v232, v232
    v_mfma_f32_16x16x32_bf16 v[84:87], v[136:139], v[204:207], v[84:87]
    v_and_b32 v233, 0xffff0000, v18
    v_lshlrev_b32 v49, 16, v18
    v_rcp_f32 v233, v233
    v_mfma_f32_16x16x32_bf16 v[88:91], v[136:139], v[208:211], v[88:91]
    v_and_b32 v234, 0xffff0000, v20
    v_lshlrev_b32 v50, 16, v20
    v_rcp_f32 v234, v234
    v_mfma_f32_16x16x32_bf16 v[92:95], v[136:139], v[212:215], v[92:95]
    v_and_b32 v235, 0xffff0000, v22
    v_lshlrev_b32 v51, 16, v22
    v_rcp_f32 v235, v235
    v_mfma_f32_16x16x32_bf16 v[76:79], v[140:143], v[192:195], v[76:79]
    v_and_b32 v236, 0xffff0000, v24
    v_lshlrev_b32 v52, 16, v24
    v_rcp_f32 v236, v236
    v_mfma_f32_16x16x32_bf16 v[80:83], v[140:143], v[196:199], v[80:83]
    v_and_b32 v237, 0xffff0000, v26
    v_lshlrev_b32 v53, 16, v26
    v_rcp_f32 v237, v237
    v_mfma_f32_16x16x32_bf16 v[84:87], v[140:143], v[200:203], v[84:87]
    v_and_b32 v238, 0xffff0000, v28
    v_lshlrev_b32 v54, 16, v28
    v_rcp_f32 v238, v238
    v_mfma_f32_16x16x32_bf16 v[88:91], v[140:143], v[204:207], v[88:91]
    v_and_b32 v239, 0xffff0000, v30
    v_lshlrev_b32 v55, 16, v30
    v_rcp_f32 v239, v239
    v_mfma_f32_16x16x32_bf16 v[92:95], v[140:143], v[208:211], v[92:95]
    v_and_b32 v240, 0xffff0000, v32
    v_lshlrev_b32 v56, 16, v32
    v_rcp_f32 v240, v240
    v_mfma_f32_16x16x32_bf16 v[80:83], v[144:147], v[192:195], v[80:83]
    v_and_b32 v241, 0xffff0000, v34
    v_lshlrev_b32 v57, 16, v34
    v_rcp_f32 v241, v241
    v_mfma_f32_16x16x32_bf16 v[84:87], v[144:147], v[196:199], v[84:87]
    v_and_b32 v242, 0xffff0000, v36
    v_lshlrev_b32 v58, 16, v36
    v_rcp_f32 v242, v242
    v_mfma_f32_16x16x32_bf16 v[88:91], v[144:147], v[200:203], v[88:91]
    v_and_b32 v243, 0xffff0000, v38
    v_lshlrev_b32 v59, 16, v38
    v_rcp_f32 v243, v243
    v_mfma_f32_16x16x32_bf16 v[92:95], v[144:147], v[204:207], v[92:95]
    v_and_b32 v244, 0xffff0000, v40
    v_lshlrev_b32 v60, 16, v40
    v_rcp_f32 v244, v244
    v_mfma_f32_16x16x32_bf16 v[84:87], v[148:151], v[192:195], v[84:87]
    v_and_b32 v245, 0xffff0000, v42
    v_lshlrev_b32 v61, 16, v42
    v_rcp_f32 v245, v245
    v_mfma_f32_16x16x32_bf16 v[88:91], v[148:151], v[196:199], v[88:91]
    v_and_b32 v246, 0xffff0000, v44
    v_lshlrev_b32 v62, 16, v44
    v_rcp_f32 v246, v246
    v_mfma_f32_16x16x32_bf16 v[92:95], v[148:151], v[200:203], v[92:95]
    v_and_b32 v247, 0xffff0000, v46
    v_lshlrev_b32 v63, 16, v46
    v_rcp_f32 v247, v247
    v_mfma_f32_16x16x32_bf16 v[88:91], v[152:155], v[192:195], v[88:91]
    v_mfma_f32_16x16x32_bf16 v[92:95], v[152:155], v[196:199], v[92:95]
    v_mfma_f32_16x16x32_bf16 v[92:95], v[156:159], v[192:195], v[92:95]
    v_lshlrev_b32 v8, 4, v1
    s_lshl_b32 s83, s4, 12
    s_add_u32 s83, s83, 58880
    v_add_u32 v9, s83, v8
    s_xor_b32 s84, s4, 1
    s_lshl_b32 s84, s84, 12
    s_add_u32 s84, s84, 58880
    v_add_u32 v8, s84, v8
    s_cmp_eq_u32 s9, 0
    s_cbranch_scc1 C_P0
    ds_write_b128 v9, v[64:67] offset:0
    ds_write_b128 v9, v[68:71] offset:1024
    ds_write_b128 v9, v[72:75] offset:2048
    ds_write_b128 v9, v[76:79] offset:3072
    s_nop 1
    v_mov_b64 v[64:65], v[80:81]
    v_mov_b64 v[66:67], v[82:83]
    v_mov_b64 v[68:69], v[84:85]
    v_mov_b64 v[70:71], v[86:87]
    v_mov_b64 v[72:73], v[88:89]
    v_mov_b64 v[74:75], v[90:91]
    v_mov_b64 v[76:77], v[92:93]
    v_mov_b64 v[78:79], v[94:95]
    s_branch C_PJ
C_P0:
    s_nop 7
    ds_write_b128 v9, v[80:83] offset:0
    ds_write_b128 v9, v[84:87] offset:1024
    ds_write_b128 v9, v[88:91] offset:2048
    ds_write_b128 v9, v[92:95] offset:3072
C_PJ:
    s_and_b32 s83, s10, 2
    v_and_b32 v5, 3, v11
    v_xor_b32 v5, s83, v5
    v_lshlrev_b32 v5, 5, v5
    v_lshl_add_u32 v5, v12, 3, v5
    v_lshrrev_b32 v9, 2, v11
    v_lshl_add_u32 v5, v9, 16, v5
    s_lshl_b32 s83, s10, 7
    s_lshl_b32 s84, s9, 20
    s_add_u32 s83, s83, s84
    s_add_u32 s83, s83, 5242880
    v_add_u32 v5, s83, v5
    s_mov_b32 s88, 0
    s_mov_b32 s89, 262144
    s_mov_b32 s90, 524288
    s_mov_b32 s91, 786432
    s_waitcnt lgkmcnt(0)
    s_barrier
    ds_read_b128 v[160:163], v8 offset:0
    ds_read_b128 v[164:167], v8 offset:1024
    ds_read_b128 v[168:171], v8 offset:2048
    ds_read_b128 v[172:175], v8 offset:3072
    v_and_b32 v120, 0xffff0000, v113
    v_lshlrev_b32 v121, 16, v113
    v_and_b32 v122, 0xffff0000, v112
    v_lshlrev_b32 v123, 16, v112
    v_lshlrev_b32 v176, 16, v224
    v_and_b32 v177, 0xffff0000, v224
    v_lshlrev_b32 v178, 16, v225
    v_and_b32 v179, 0xffff0000, v225
    v_pk_fma_f32 v[64:65], v[120:121], v[14:15], v[64:65] op_sel:[0,1,0] op_sel_hi:[1,1,1]
    v_pk_fma_f32 v[66:67], v[122:123], v[14:15], v[66:67] op_sel:[0,1,0] op_sel_hi:[1,1,1]
    v_pk_add_f32 v[136:137], v[176:177], v[48:49] neg_lo:[0,1] neg_hi:[0,1]
    v_pk_add_f32 v[138:139], v[178:179], v[50:51] neg_lo:[0,1] neg_hi:[0,1]
    v_pk_mul_f32 v[136:137], v[136:137], v[232:233]
    v_pk_mul_f32 v[138:139], v[138:139], v[234:235]
    v_and_b32 v120, 0xffff0000, v115
    v_lshlrev_b32 v121, 16, v115
    v_and_b32 v122, 0xffff0000, v114
    v_lshlrev_b32 v123, 16, v114
    v_lshlrev_b32 v180, 16, v226
    v_and_b32 v181, 0xffff0000, v226
    v_lshlrev_b32 v182, 16, v227
    v_and_b32 v183, 0xffff0000, v227
    v_pk_fma_f32 v[68:69], v[120:121], v[14:15], v[68:69] op_sel:[0,1,0] op_sel_hi:[1,1,1]
    v_pk_fma_f32 v[70:71], v[122:123], v[14:15], v[70:71] op_sel:[0,1,0] op_sel_hi:[1,1,1]
    v_pk_add_f32 v[140:141], v[180:181], v[52:53] neg_lo:[0,1] neg_hi:[0,1]
    v_pk_add_f32 v[142:143], v[182:183], v[54:55] neg_lo:[0,1] neg_hi:[0,1]
    v_pk_mul_f32 v[140:141], v[140:141], v[236:237]
    v_pk_mul_f32 v[142:143], v[142:143], v[238:239]
    v_and_b32 v120, 0xffff0000, v117
    v_lshlrev_b32 v121, 16, v117
    v_and_b32 v122, 0xffff0000, v116
    v_lshlrev_b32 v123, 16, v116
    v_lshlrev_b32 v184, 16, v228
    v_and_b32 v185, 0xffff0000, v228
    v_lshlrev_b32 v186, 16, v229
    v_and_b32 v187, 0xffff0000, v229
    v_pk_fma_f32 v[72:73], v[120:121], v[14:15], v[72:73] op_sel:[0,1,0] op_sel_hi:[1,1,1]
    v_pk_fma_f32 v[74:75], v[122:123], v[14:15], v[74:75] op_sel:[0,1,0] op_sel_hi:[1,1,1]
    v_pk_add_f32 v[144:145], v[184:185], v[56:57] neg_lo:[0,1] neg_hi:[0,1]
    v_pk_add_f32 v[146:147], v[186:187], v[58:59] neg_lo:[0,1] neg_hi:[0,1]
    v_pk_mul_f32 v[144:145], v[144:145], v[240:241]
    v_pk_mul_f32 v[146:147], v[146:147], v[242:243]
    v_and_b32 v120, 0xffff0000, v119
    v_lshlrev_b32 v121, 16, v119
    v_and_b32 v122, 0xffff0000, v118
    v_lshlrev_b32 v123, 16, v118
    v_lshlrev_b32 v188, 16, v230
    v_and_b32 v189, 0xffff0000, v230
    v_lshlrev_b32 v190, 16, v231
    v_and_b32 v191, 0xffff0000, v231
    v_pk_fma_f32 v[76:77], v[120:121], v[14:15], v[76:77] op_sel:[0,1,0] op_sel_hi:[1,1,1]
    v_pk_fma_f32 v[78:79], v[122:123], v[14:15], v[78:79] op_sel:[0,1,0] op_sel_hi:[1,1,1]
    v_pk_add_f32 v[148:149], v[188:189], v[60:61] neg_lo:[0,1] neg_hi:[0,1]
    v_pk_add_f32 v[150:151], v[190:191], v[62:63] neg_lo:[0,1] neg_hi:[0,1]
    v_pk_mul_f32 v[148:149], v[148:149], v[244:245]
    v_pk_mul_f32 v[150:151], v[150:151], v[246:247]
    s_waitcnt lgkmcnt(3)
    v_pk_add_f32 v[64:65], v[64:65], v[160:161]
    v_pk_add_f32 v[66:67], v[66:67], v[162:163]
    v_pk_fma_f32 v[136:137], v[136:137], v[64:65], v[176:177]
    v_pk_fma_f32 v[138:139], v[138:139], v[66:67], v[178:179]
    v_cvt_pk_bf16_f32 v128, v136, v137
    v_cvt_pk_bf16_f32 v129, v138, v139
    buffer_store_dwordx2 v[128:129], v5, s[28:31], s88 offen sc1
    s_waitcnt lgkmcnt(2)
    v_pk_add_f32 v[68:69], v[68:69], v[164:165]
    v_pk_add_f32 v[70:71], v[70:71], v[166:167]
    v_pk_fma_f32 v[140:141], v[140:141], v[68:69], v[180:181]
    v_pk_fma_f32 v[142:143], v[142:143], v[70:71], v[182:183]
    v_cvt_pk_bf16_f32 v130, v140, v141
    v_cvt_pk_bf16_f32 v131, v142, v143
    buffer_store_dwordx2 v[130:131], v5, s[28:31], s89 offen sc1
    s_waitcnt lgkmcnt(1)
    v_pk_add_f32 v[72:73], v[72:73], v[168:169]
    v_pk_add_f32 v[74:75], v[74:75], v[170:171]
    v_pk_fma_f32 v[144:145], v[144:145], v[72:73], v[184:185]
    v_pk_fma_f32 v[146:147], v[146:147], v[74:75], v[186:187]
    v_cvt_pk_bf16_f32 v132, v144, v145
    v_cvt_pk_bf16_f32 v133, v146, v147
    buffer_store_dwordx2 v[132:133], v5, s[28:31], s90 offen sc1
    s_waitcnt lgkmcnt(0)
    v_pk_add_f32 v[76:77], v[76:77], v[172:173]
    v_pk_add_f32 v[78:79], v[78:79], v[174:175]
    v_pk_fma_f32 v[148:149], v[148:149], v[76:77], v[188:189]
    v_pk_fma_f32 v[150:151], v[150:151], v[78:79], v[190:191]
    v_cvt_pk_bf16_f32 v134, v148, v149
    v_cvt_pk_bf16_f32 v135, v150, v151
    buffer_store_dwordx2 v[134:135], v5, s[28:31], s91 offen sc1
    v_add_u32 v12, s19, v3
    v_add_u32 v13, s19, v4
    s_waitcnt vmcnt(4)
    ds_read_b64_tr_b16 a[0:1], v12 offset:0
    ds_read_b64_tr_b16 a[2:3], v12 offset:1024
    ds_read_b64_tr_b16 a[4:5], v13 offset:0
    ds_read_b64_tr_b16 a[6:7], v13 offset:1024
    ds_read_b64_tr_b16 a[8:9], v12 offset:2048
    ds_read_b64_tr_b16 a[10:11], v12 offset:3072
    ds_read_b64_tr_b16 a[12:13], v13 offset:2048
    ds_read_b64_tr_b16 a[14:15], v13 offset:3072
    ds_read_b64_tr_b16 a[16:17], v12 offset:4096
    ds_read_b64_tr_b16 a[18:19], v12 offset:5120
    ds_read_b64_tr_b16 a[20:21], v13 offset:4096
    ds_read_b64_tr_b16 a[22:23], v13 offset:5120
    ds_read_b64_tr_b16 a[24:25], v12 offset:6144
    ds_read_b64_tr_b16 a[26:27], v12 offset:7168
    ds_read_b64_tr_b16 a[28:29], v13 offset:6144
    ds_read_b64_tr_b16 a[30:31], v13 offset:7168
    ds_read_b64_tr_b16 a[32:33], v12 offset:8192
    ds_read_b64_tr_b16 a[34:35], v12 offset:9216
    ds_read_b64_tr_b16 a[36:37], v13 offset:8192
    ds_read_b64_tr_b16 a[38:39], v13 offset:9216
    ds_read_b64_tr_b16 a[40:41], v12 offset:10240
    ds_read_b64_tr_b16 a[42:43], v12 offset:11264
    ds_read_b64_tr_b16 a[44:45], v13 offset:10240
    ds_read_b64_tr_b16 a[46:47], v13 offset:11264
    ds_read_b64_tr_b16 a[48:49], v12 offset:12288
    ds_read_b64_tr_b16 a[50:51], v12 offset:13312
    ds_read_b64_tr_b16 a[52:53], v13 offset:12288
    ds_read_b64_tr_b16 a[54:55], v13 offset:13312
    ds_read_b64_tr_b16 a[56:57], v12 offset:14336
    ds_read_b64_tr_b16 a[58:59], v12 offset:15360
    ds_read_b64_tr_b16 a[60:61], v13 offset:14336
    ds_read_b64_tr_b16 a[62:63], v13 offset:15360
    ds_read_b64_tr_b16 a[64:65], v12 offset:16384
    ds_read_b64_tr_b16 a[66:67], v12 offset:17408
    ds_read_b64_tr_b16 a[68:69], v13 offset:16384
    ds_read_b64_tr_b16 a[70:71], v13 offset:17408
    ds_read_b64_tr_b16 a[72:73], v12 offset:18432
    ds_read_b64_tr_b16 a[74:75], v12 offset:19456
    ds_read_b64_tr_b16 a[76:77], v13 offset:18432
    ds_read_b64_tr_b16 a[78:79], v13 offset:19456
    s_add_u32 s76, s3, 256
    s_lshl_b32 s77, s6, 2
    s_add_u32 s77, s77, s76
    s_lshl_b32 s78, s4, 13
    s_add_u32 s78, s78, 131072
    v_add_u32 v12, s78, v3
    v_add_u32 v13, s78, v4
    v_lshrrev_b32 v5, 2, v1
    v_mul_u32_u24 v5, 3584, v5
    v_and_b32 v6, 3, v1
    v_lshl_add_u32 v5, v6, 4, v5
    s_lshl_b32 s79, s13, 6
    v_add_u32 v5, s79, v5
    s_and_b32 s20, s12, 3
    s_lshl_b32 s79, s20, 3
    s_lshl_b32 s80, s4, 15
    v_bfe_u32 v14, v1, 2, 2
    v_bfe_u32 v7, v1, 4, 1
    v_lshrrev_b32 v8, 5, v1
    v_lshlrev_b32 v9, 3, v8
    v_add_u32 v9, v9, v14
    v_lshlrev_b32 v9, 6, v9
    v_lshl_add_u32 v9, v7, 5, v9
    v_lshl_add_u32 v9, v6, 3, v9
    v_add_u32 v9, s80, v9
    v_add_u32 v14, s80, v3
    v_add_u32 v15, s80, v4
    v_mov_b32 v10, 0
    v_mov_b32 v11, 0x3f803f80
    v_mov_b32 v20, 0
    v_mov_b32 v21, 0
    v_mov_b32 v22, 0
    s_waitcnt vmcnt(0) lgkmcnt(0)
    s_barrier
    s_cmp_lg_u32 s4, 0
    s_cbranch_scc1 NW16
    v_mov_b32 v6, s7
    s_mov_b64 exec, 1
    s_cmp_eq_u32 s26, 0
    s_cbranch_scc1 FS17
    buffer_store_dword v6, off, s[28:31], s77
    s_branch FS18
FS17:
    buffer_store_dword v6, off, s[28:31], s77 sc1
FS18:
    s_mov_b64 exec, -1
NW16:
    s_cmp_ge_u32 s12, 14
    s_cbranch_scc1 B_STATS
    s_mov_b32 m0, s80
    s_mul_i32 s81, s79, 57344
    buffer_load_dwordx4 v5, s[56:59], s81 offen lds
    s_add_u32 s79, s79, 1
    s_and_b32 s79, s79, 31
    s_add_u32 m0, m0, 1024
    s_mul_i32 s81, s79, 57344
    buffer_load_dwordx4 v5, s[56:59], s81 offen lds
    s_add_u32 s79, s79, 1
    s_and_b32 s79, s79, 31
    s_add_u32 m0, m0, 1024
    s_mul_i32 s81, s79, 57344
    buffer_load_dwordx4 v5, s[56:59], s81 offen lds
    s_add_u32 s79, s79, 1
    s_and_b32 s79, s79, 31
    s_add_u32 m0, m0, 1024
    s_mul_i32 s81, s79, 57344
    buffer_load_dwordx4 v5, s[56:59], s81 offen lds
    s_add_u32 s79, s79, 1
    s_and_b32 s79, s79, 31
    s_add_u32 m0, m0, 1024
    s_mul_i32 s81, s79, 57344
    buffer_load_dwordx4 v5, s[56:59], s81 offen lds
    s_add_u32 s79, s79, 1
    s_and_b32 s79, s79, 31
    s_add_u32 m0, m0, 1024
    s_mul_i32 s81, s79, 57344
    buffer_load_dwordx4 v5, s[56:59], s81 offen lds
    s_add_u32 s79, s79, 1
    s_and_b32 s79, s79, 31
    s_add_u32 m0, m0, 1024
    s_mul_i32 s81, s79, 57344
    buffer_load_dwordx4 v5, s[56:59], s81 offen lds
    s_add_u32 s79, s79, 1
    s_and_b32 s79, s79, 31
    s_add_u32 m0, m0, 1024
    s_mul_i32 s81, s79, 57344
    buffer_load_dwordx4 v5, s[56:59], s81 offen lds
    s_add_u32 s79, s79, 1
    s_and_b32 s79, s79, 31
    s_add_u32 m0, m0, 1024
    s_mul_i32 s81, s79, 57344
    buffer_load_dwordx4 v5, s[56:59], s81 offen lds
    s_add_u32 s79, s79, 1
    s_and_b32 s79, s79, 31
    s_add_u32 m0, m0, 1024
    s_mul_i32 s81, s79, 57344
    buffer_load_dwordx4 v5, s[56:59], s81 offen lds
    s_add_u32 s79, s79, 1
    s_and_b32 s79, s79, 31
    s_add_u32 m0, m0, 1024
    s_mul_i32 s81, s79, 57344
    buffer_load_dwordx4 v5, s[56:59], s81 offen lds
    s_add_u32 s79, s79, 1
    s_and_b32 s79, s79, 31
    s_add_u32 m0, m0, 1024
    s_mul_i32 s81, s79, 57344
    buffer_load_dwordx4 v5, s[56:59], s81 offen lds
    s_add_u32 s79, s79, 1
    s_and_b32 s79, s79, 31
    s_add_u32 m0, m0, 1024
    s_mul_i32 s81, s79, 57344
    buffer_load_dwordx4 v5, s[56:59], s81 offen lds
    s_add_u32 s79, s79, 1
    s_and_b32 s79, s79, 31
    s_add_u32 m0, m0, 1024
    s_mul_i32 s81, s79, 57344
    buffer_load_dwordx4 v5, s[56:59], s81 offen lds
    s_add_u32 s79, s79, 1
    s_and_b32 s79, s79, 31
    s_add_u32 m0, m0, 1024
    s_mul_i32 s81, s79, 57344
    buffer_load_dwordx4 v5, s[56:59], s81 offen lds
    s_add_u32 s79, s79, 1
    s_and_b32 s79, s79, 31
    s_add_u32 m0, m0, 1024
    s_mul_i32 s81, s79, 57344
    buffer_load_dwordx4 v5, s[56:59], s81 offen lds
    s_add_u32 s79, s79, 1
    s_and_b32 s79, s79, 31
    s_add_u32 m0, m0, 1024
    s_mul_i32 s81, s79, 57344
    buffer_load_dwordx4 v5, s[56:59], s81 offen lds
    s_add_u32 s79, s79, 1
    s_and_b32 s79, s79, 31
    s_add_u32 m0, m0, 1024
    s_mul_i32 s81, s79, 57344
    buffer_load_dwordx4 v5, s[56:59], s81 offen lds
    s_add_u32 s79, s79, 1
    s_and_b32 s79, s79, 31
    s_add_u32 m0, m0, 1024
    s_mul_i32 s81, s79, 57344
    buffer_load_dwordx4 v5, s[56:59], s81 offen lds
    s_add_u32 s79, s79, 1
    s_and_b32 s79, s79, 31
    s_add_u32 m0, m0, 1024
    s_mul_i32 s81, s79, 57344
    buffer_load_dwordx4 v5, s[56:59], s81 offen lds
    s_add_u32 s79, s79, 1
    s_and_b32 s79, s79, 31
    s_add_u32 m0, m0, 1024
    s_mul_i32 s81, s79, 57344
    buffer_load_dwordx4 v5, s[56:59], s81 offen lds
    s_add_u32 s79, s79, 1
    s_and_b32 s79, s79, 31
    s_add_u32 m0, m0, 1024
    s_mul_i32 s81, s79, 57344
    buffer_load_dwordx4 v5, s[56:59], s81 offen lds
    s_add_u32 s79, s79, 1
    s_and_b32 s79, s79, 31
    s_add_u32 m0, m0, 1024
    s_mul_i32 s81, s79, 57344
    buffer_load_dwordx4 v5, s[56:59], s81 offen lds
    s_add_u32 s79, s79, 1
    s_and_b32 s79, s79, 31
    s_add_u32 m0, m0, 1024
    s_mul_i32 s81, s79, 57344
    buffer_load_dwordx4 v5, s[56:59], s81 offen lds
    s_add_u32 s79, s79, 1
    s_and_b32 s79, s79, 31
    s_add_u32 m0, m0, 1024
    s_mul_i32 s81, s79, 57344
    buffer_load_dwordx4 v5, s[56:59], s81 offen lds
    s_add_u32 s79, s79, 1
    s_and_b32 s79, s79, 31
    s_add_u32 m0, m0, 1024
    s_mul_i32 s81, s79, 57344
    buffer_load_dwordx4 v5, s[56:59], s81 offen lds
    s_add_u32 s79, s79, 1
    s_and_b32 s79, s79, 31
    s_add_u32 m0, m0, 1024
    s_mul_i32 s81, s79, 57344
    buffer_load_dwordx4 v5, s[56:59], s81 offen lds
    s_add_u32 s79, s79, 1
    s_and_b32 s79, s79, 31
    s_add_u32 m0, m0, 1024
    s_mul_i32 s81, s79, 57344
    buffer_load_dwordx4 v5, s[56:59], s81 offen lds
    s_add_u32 s79, s79, 1
    s_and_b32 s79, s79, 31
    s_add_u32 m0, m0, 1024
    s_mul_i32 s81, s79, 57344
    buffer_load_dwordx4 v5, s[56:59], s81 offen lds
    s_add_u32 s79, s79, 1
    s_and_b32 s79, s79, 31
    s_add_u32 m0, m0, 1024
    s_mul_i32 s81, s79, 57344
    buffer_load_dwordx4 v5, s[56:59], s81 offen lds
    s_add_u32 s79, s79, 1
    s_and_b32 s79, s79, 31
    s_add_u32 m0, m0, 1024
    s_mul_i32 s81, s79, 57344
    buffer_load_dwordx4 v5, s[56:59], s81 offen lds
    s_add_u32 s79, s79, 1
    s_and_b32 s79, s79, 31
    s_add_u32 m0, m0, 1024
    s_mul_i32 s81, s79, 57344
    buffer_load_dwordx4 v5, s[56:59], s81 offen lds
    s_add_u32 s79, s79, 1
    s_and_b32 s79, s79, 31
    s_add_u32 m0, m0, 1024
    s_mov_b32 m0, s78
    s_nop 0
    buffer_load_dwordx4 v2, s[60:63], s18 offen lds
    s_add_u32 s18, s18, 8192
    s_add_u32 m0, m0, 1024
    s_cmp_eq_u32 s18, s22
    s_cselect_b32 s97, 458752, 0
    s_sub_u32 s18, s18, s97
    buffer_load_dwordx4 v2, s[60:63], s18 offen lds
    s_add_u32 s18, s18, 8192
    s_add_u32 m0, m0, 1024
    s_cmp_eq_u32 s18, s22
    s_cselect_b32 s97, 458752, 0
    s_sub_u32 s18, s18, s97
    buffer_load_dwordx4 v2, s[60:63], s18 offen lds
    s_add_u32 s18, s18, 8192
    s_add_u32 m0, m0, 1024
    s_cmp_eq_u32 s18, s22
    s_cselect_b32 s97, 458752, 0
    s_sub_u32 s18, s18, s97
    buffer_load_dwordx4 v2, s[60:63], s18 offen lds
    s_add_u32 s18, s18, 8192
    s_add_u32 m0, m0, 1024
    s_cmp_eq_u32 s18, s22
    s_cselect_b32 s97, 458752, 0
    s_sub_u32 s18, s18, s97
    buffer_load_dwordx4 v2, s[60:63], s18 offen lds
    s_add_u32 s18, s18, 8192
    s_add_u32 m0, m0, 1024
    s_cmp_eq_u32 s18, s22
    s_cselect_b32 s97, 458752, 0
    s_sub_u32 s18, s18, s97
    buffer_load_dwordx4 v2, s[60:63], s18 offen lds
    s_add_u32 s18, s18, 8192
    s_add_u32 m0, m0, 1024
    s_cmp_eq_u32 s18, s22
    s_cselect_b32 s97, 458752, 0
    s_sub_u32 s18, s18, s97
    buffer_load_dwordx4 v2, s[60:63], s18 offen lds
    s_add_u32 s18, s18, 8192
    s_add_u32 m0, m0, 1024
    s_cmp_eq_u32 s18, s22
    s_cselect_b32 s97, 458752, 0
    s_sub_u32 s18, s18, s97
    buffer_load_dwordx4 v2, s[60:63], s18 offen lds
    s_add_u32 s18, s18, 8192
    s_add_u32 m0, m0, 1024
    s_cmp_eq_u32 s18, s22
    s_cselect_b32 s97, 458752, 0
    s_sub_u32 s18, s18, s97
    s_waitcnt vmcnt(32)
    ds_read_b64_tr_b16 v[128:129], v9 offset:0
    ds_read_b64_tr_b16 v[130:131], v9 offset:256
    ds_read_b64_tr_b16 v[132:133], v9 offset:1024
    ds_read_b64_tr_b16 v[134:135], v9 offset:1280
    ds_read_b64_tr_b16 v[136:137], v9 offset:2048
    ds_read_b64_tr_b16 v[138:139], v9 offset:2304
    ds_read_b64_tr_b16 v[140:141], v9 offset:3072
    ds_read_b64_tr_b16 v[142:143], v9 offset:3328
    ds_read_b64_tr_b16 v[144:145], v9 offset:4096
    ds_read_b64_tr_b16 v[146:147], v9 offset:4352
    ds_read_b64_tr_b16 v[148:149], v9 offset:5120
    ds_read_b64_tr_b16 v[150:151], v9 offset:5376
    ds_read_b64_tr_b16 v[152:153], v9 offset:6144
    ds_read_b64_tr_b16 v[154:155], v9 offset:6400
    ds_read_b64_tr_b16 v[156:157], v9 offset:7168
    ds_read_b64_tr_b16 v[158:159], v9 offset:7424
    s_waitcnt vmcnt(24)
    ds_read_b64_tr_b16 v[160:161], v9 offset:8192
    ds_read_b64_tr_b16 v[162:163], v9 offset:8448
    ds_read_b64_tr_b16 v[164:165], v9 offset:9216
    ds_read_b64_tr_b16 v[166:167], v9 offset:9472
    ds_read_b64_tr_b16 v[168:169], v9 offset:10240
    ds_read_b64_tr_b16 v[170:171], v9 offset:10496
    ds_read_b64_tr_b16 v[172:173], v9 offset:11264
    ds_read_b64_tr_b16 v[174:175], v9 offset:11520
    ds_read_b64_tr_b16 v[176:177], v9 offset:12288
    ds_read_b64_tr_b16 v[178:179], v9 offset:12544
    ds_read_b64_tr_b16 v[180:181], v9 offset:13312
    ds_read_b64_tr_b16 v[182:183], v9 offset:13568
    ds_read_b64_tr_b16 v[184:185], v9 offset:14336
    ds_read_b64_tr_b16 v[186:187], v9 offset:14592
    ds_read_b64_tr_b16 v[188:189], v9 offset:15360
    ds_read_b64_tr_b16 v[190:191], v9 offset:15616
    s_waitcnt lgkmcnt(15)
    v_dot2c_f32_bf16 v10, v128, v11
    v_dot2c_f32_bf16 v20, v129, v11
    v_dot2c_f32_bf16 v21, v130, v11
    v_dot2c_f32_bf16 v22, v131, v11
    v_dot2c_f32_bf16 v10, v132, v11
    v_dot2c_f32_bf16 v20, v133, v11
    v_dot2c_f32_bf16 v21, v134, v11
    v_dot2c_f32_bf16 v22, v135, v11
    v_dot2c_f32_bf16 v10, v136, v11
    v_dot2c_f32_bf16 v20, v137, v11
    v_dot2c_f32_bf16 v21, v138, v11
    v_dot2c_f32_bf16 v22, v139, v11
    v_dot2c_f32_bf16 v10, v140, v11
    v_dot2c_f32_bf16 v20, v141, v11
    v_dot2c_f32_bf16 v21, v142, v11
    v_dot2c_f32_bf16 v22, v143, v11
    v_dot2c_f32_bf16 v10, v144, v11
    v_dot2c_f32_bf16 v20, v145, v11
    v_dot2c_f32_bf16 v21, v146, v11
    v_dot2c_f32_bf16 v22, v147, v11
    v_dot2c_f32_bf16 v10, v148, v11
    v_dot2c_f32_bf16 v20, v149, v11
    v_dot2c_f32_bf16 v21, v150, v11
    v_dot2c_f32_bf16 v22, v151, v11
    v_dot2c_f32_bf16 v10, v152, v11
    v_dot2c_f32_bf16 v20, v153, v11
    v_dot2c_f32_bf16 v21, v154, v11
    v_dot2c_f32_bf16 v22, v155, v11
    v_dot2c_f32_bf16 v10, v156, v11
    v_dot2c_f32_bf16 v20, v157, v11
    v_dot2c_f32_bf16 v21, v158, v11
    v_dot2c_f32_bf16 v22, v159, v11
    s_waitcnt vmcnt(16)
    ds_read_b64_tr_b16 v[192:193], v9 offset:16384
    ds_read_b64_tr_b16 v[194:195], v9 offset:16640
    ds_read_b64_tr_b16 v[196:197], v9 offset:17408
    ds_read_b64_tr_b16 v[198:199], v9 offset:17664
    ds_read_b64_tr_b16 v[200:201], v9 offset:18432
    ds_read_b64_tr_b16 v[202:203], v9 offset:18688
    ds_read_b64_tr_b16 v[204:205], v9 offset:19456
    ds_read_b64_tr_b16 v[206:207], v9 offset:19712
    ds_read_b64_tr_b16 v[208:209], v9 offset:20480
    ds_read_b64_tr_b16 v[210:211], v9 offset:20736
    ds_read_b64_tr_b16 v[212:213], v9 offset:21504
    ds_read_b64_tr_b16 v[214:215], v9 offset:21760
    ds_read_b64_tr_b16 v[216:217], v9 offset:22528
    ds_read_b64_tr_b16 v[218:219], v9 offset:22784
    ds_read_b64_tr_b16 v[220:221], v9 offset:23552
    ds_read_b64_tr_b16 v[222:223], v9 offset:23808
    s_waitcnt lgkmcnt(15)
    v_dot2c_f32_bf16 v10, v160, v11
    v_dot2c_f32_bf16 v20, v161, v11
    v_dot2c_f32_bf16 v21, v162, v11
    v_dot2c_f32_bf16 v22, v163, v11
    v_dot2c_f32_bf16 v10, v164, v11
    v_dot2c_f32_bf16 v20, v165, v11
    v_dot2c_f32_bf16 v21, v166, v11
    v_dot2c_f32_bf16 v22, v167, v11
    v_dot2c_f32_bf16 v10, v168, v11
    v_dot2c_f32_bf16 v20, v169, v11
    v_dot2c_f32_bf16 v21, v170, v11
    v_dot2c_f32_bf16 v22, v171, v11
    v_dot2c_f32_bf16 v10, v172, v11
    v_dot2c_f32_bf16 v20, v173, v11
    v_dot2c_f32_bf16 v21, v174, v11
    v_dot2c_f32_bf16 v22, v175, v11
    v_dot2c_f32_bf16 v10, v176, v11
    v_dot2c_f32_bf16 v20, v177, v11
    v_dot2c_f32_bf16 v21, v178, v11
    v_dot2c_f32_bf16 v22, v179, v11
    v_dot2c_f32_bf16 v10, v180, v11
    v_dot2c_f32_bf16 v20, v181, v11
    v_dot2c_f32_bf16 v21, v182, v11
    v_dot2c_f32_bf16 v22, v183, v11
    v_dot2c_f32_bf16 v10, v184, v11
    v_dot2c_f32_bf16 v20, v185, v11
    v_dot2c_f32_bf16 v21, v186, v11
    v_dot2c_f32_bf16 v22, v187, v11
    v_dot2c_f32_bf16 v10, v188, v11
    v_dot2c_f32_bf16 v20, v189, v11
    v_dot2c_f32_bf16 v21, v190, v11
    v_dot2c_f32_bf16 v22, v191, v11
    s_waitcnt vmcnt(8)
    ds_read_b64_tr_b16 v[224:225], v9 offset:24576
    ds_read_b64_tr_b16 v[226:227], v9 offset:24832
    ds_read_b64_tr_b16 v[228:229], v9 offset:25600
    ds_read_b64_tr_b16 v[230:231], v9 offset:25856
    ds_read_b64_tr_b16 v[232:233], v9 offset:26624
    ds_read_b64_tr_b16 v[234:235], v9 offset:26880
    ds_read_b64_tr_b16 v[236:237], v9 offset:27648
    ds_read_b64_tr_b16 v[238:239], v9 offset:27904
    ds_read_b64_tr_b16 v[240:241], v9 offset:28672
    ds_read_b64_tr_b16 v[242:243], v9 offset:28928
    ds_read_b64_tr_b16 v[244:245], v9 offset:29696
    ds_read_b64_tr_b16 v[246:247], v9 offset:29952
    ds_read_b64_tr_b16 v[248:249], v9 offset:30720
    ds_read_b64_tr_b16 v[250:251], v9 offset:30976
    ds_read_b64_tr_b16 v[252:253], v9 offset:31744
    ds_read_b64_tr_b16 v[254:255], v9 offset:32000
    s_waitcnt lgkmcnt(15)
    v_dot2c_f32_bf16 v10, v192, v11
    v_dot2c_f32_bf16 v20, v193, v11
    v_dot2c_f32_bf16 v21, v194, v11
    v_dot2c_f32_bf16 v22, v195, v11
    v_dot2c_f32_bf16 v10, v196, v11
    v_dot2c_f32_bf16 v20, v197, v11
    v_dot2c_f32_bf16 v21, v198, v11
    v_dot2c_f32_bf16 v22, v199, v11
    v_dot2c_f32_bf16 v10, v200, v11
    v_dot2c_f32_bf16 v20, v201, v11
    v_dot2c_f32_bf16 v21, v202, v11
    v_dot2c_f32_bf16 v22, v203, v11
    v_dot2c_f32_bf16 v10, v204, v11
    v_dot2c_f32_bf16 v20, v205, v11
    v_dot2c_f32_bf16 v21, v206, v11
    v_dot2c_f32_bf16 v22, v207, v11
    v_dot2c_f32_bf16 v10, v208, v11
    v_dot2c_f32_bf16 v20, v209, v11
    v_dot2c_f32_bf16 v21, v210, v11
    v_dot2c_f32_bf16 v22, v211, v11
    v_dot2c_f32_bf16 v10, v212, v11
    v_dot2c_f32_bf16 v20, v213, v11
    v_dot2c_f32_bf16 v21, v214, v11
    v_dot2c_f32_bf16 v22, v215, v11
    v_dot2c_f32_bf16 v10, v216, v11
    v_dot2c_f32_bf16 v20, v217, v11
    v_dot2c_f32_bf16 v21, v218, v11
    v_dot2c_f32_bf16 v22, v219, v11
    v_dot2c_f32_bf16 v10, v220, v11
    v_dot2c_f32_bf16 v20, v221, v11
    v_dot2c_f32_bf16 v21, v222, v11
    v_dot2c_f32_bf16 v22, v223, v11
    s_waitcnt vmcnt(0)
    ds_read_b64_tr_b16 a[80:81], v12 offset:0
    ds_read_b64_tr_b16 a[82:83], v12 offset:1024
    ds_read_b64_tr_b16 a[84:85], v13 offset:0
    ds_read_b64_tr_b16 a[86:87], v13 offset:1024
    ds_read_b64_tr_b16 a[88:89], v12 offset:2048
    ds_read_b64_tr_b16 a[90:91], v12 offset:3072
    ds_read_b64_tr_b16 a[92:93], v13 offset:2048
    ds_read_b64_tr_b16 a[94:95], v13 offset:3072
    ds_read_b64_tr_b16 a[96:97], v12 offset:4096
    ds_read_b64_tr_b16 a[98:99], v12 offset:5120
    ds_read_b64_tr_b16 a[100:101], v13 offset:4096
    ds_read_b64_tr_b16 a[102:103], v13 offset:5120
    ds_read_b64_tr_b16 a[104:105], v12 offset:6144
    ds_read_b64_tr_b16 a[106:107], v12 offset:7168
    ds_read_b64_tr_b16 a[108:109], v13 offset:6144
    ds_read_b64_tr_b16 a[110:111], v13 offset:7168
    s_waitcnt lgkmcnt(15)
    v_dot2c_f32_bf16 v10, v224, v11
    v_dot2c_f32_bf16 v20, v225, v11
    v_dot2c_f32_bf16 v21, v226, v11
    v_dot2c_f32_bf16 v22, v227, v11
    v_dot2c_f32_bf16 v10, v228, v11
    v_dot2c_f32_bf16 v20, v229, v11
    v_dot2c_f32_bf16 v21, v230, v11
    v_dot2c_f32_bf16 v22, v231, v11
    v_dot2c_f32_bf16 v10, v232, v11
    v_dot2c_f32_bf16 v20, v233, v11
    v_dot2c_f32_bf16 v21, v234, v11
    v_dot2c_f32_bf16 v22, v235, v11
    v_dot2c_f32_bf16 v10, v236, v11
    v_dot2c_f32_bf16 v20, v237, v11
    v_dot2c_f32_bf16 v21, v238, v11
    v_dot2c_f32_bf16 v22, v239, v11
    v_dot2c_f32_bf16 v10, v240, v11
    v_dot2c_f32_bf16 v20, v241, v11
    v_dot2c_f32_bf16 v21, v242, v11
    v_dot2c_f32_bf16 v22, v243, v11
    v_dot2c_f32_bf16 v10, v244, v11
    v_dot2c_f32_bf16 v20, v245, v11
    v_dot2c_f32_bf16 v21, v246, v11
    v_dot2c_f32_bf16 v22, v247, v11
    v_dot2c_f32_bf16 v10, v248, v11
    v_dot2c_f32_bf16 v20, v249, v11
    v_dot2c_f32_bf16 v21, v250, v11
    v_dot2c_f32_bf16 v22, v251, v11
    v_dot2c_f32_bf16 v10, v252, v11
    v_dot2c_f32_bf16 v20, v253, v11
    v_dot2c_f32_bf16 v21, v254, v11
    v_dot2c_f32_bf16 v22, v255, v11
    s_nop 0
    v_add_f32 v10, v10, v20
    s_nop 0
    v_add_f32 v21, v21, v22
    v_add_f32 v10, v10, v21
    v_mov_b32 v20, v10
    s_nop 1
    v_permlane32_swap_b32 v10, v20
    v_add_f32 v10, v10, v20
    v_accvgpr_write_b32 a160, v192
    v_accvgpr_write_b32 a161, v193
    v_accvgpr_write_b32 a162, v194
    v_accvgpr_write_b32 a163, v195
    v_accvgpr_write_b32 a164, v196
    v_accvgpr_write_b32 a165, v197
    v_accvgpr_write_b32 a166, v198
    v_accvgpr_write_b32 a167, v199
    v_accvgpr_write_b32 a168, v200
    v_accvgpr_write_b32 a169, v201
    v_accvgpr_write_b32 a170, v202
    v_accvgpr_write_b32 a171, v203
    v_accvgpr_write_b32 a172, v204
    v_accvgpr_write_b32 a173, v205
    v_accvgpr_write_b32 a174, v206
    v_accvgpr_write_b32 a175, v207
    v_accvgpr_write_b32 a176, v208
    v_accvgpr_write_b32 a177, v209
    v_accvgpr_write_b32 a178, v210
    v_accvgpr_write_b32 a179, v211
    v_accvgpr_write_b32 a180, v212
    v_accvgpr_write_b32 a181, v213
    v_accvgpr_write_b32 a182, v214
    v_accvgpr_write_b32 a183, v215
    v_accvgpr_write_b32 a184, v216
    v_accvgpr_write_b32 a185, v217
    v_accvgpr_write_b32 a186, v218
    v_accvgpr_write_b32 a187, v219
    v_accvgpr_write_b32 a188, v220
    v_accvgpr_write_b32 a189, v221
    v_accvgpr_write_b32 a190, v222
    v_accvgpr_write_b32 a191, v223
    v_accvgpr_write_b32 a192, v224
    v_accvgpr_write_b32 a193, v225
    v_accvgpr_write_b32 a194, v226
    v_accvgpr_write_b32 a195, v227
    v_accvgpr_write_b32 a196, v228
    v_accvgpr_write_b32 a197, v229
    v_accvgpr_write_b32 a198, v230
    v_accvgpr_write_b32 a199, v231
    v_accvgpr_write_b32 a200, v232
    v_accvgpr_write_b32 a201, v233
    v_accvgpr_write_b32 a202, v234
    v_accvgpr_write_b32 a203, v235
    v_accvgpr_write_b32 a204, v236
    v_accvgpr_write_b32 a205, v237
    v_accvgpr_write_b32 a206, v238
    v_accvgpr_write_b32 a207, v239
    v_accvgpr_write_b32 a208, v240
    v_accvgpr_write_b32 a209, v241
    v_accvgpr_write_b32 a210, v242
    v_accvgpr_write_b32 a211, v243
    v_accvgpr_write_b32 a212, v244
    v_accvgpr_write_b32 a213, v245
    v_accvgpr_write_b32 a214, v246
    v_accvgpr_write_b32 a215, v247
    v_accvgpr_write_b32 a216, v248
    v_accvgpr_write_b32 a217, v249
    v_accvgpr_write_b32 a218, v250
    v_accvgpr_write_b32 a219, v251
    v_accvgpr_write_b32 a220, v252
    v_accvgpr_write_b32 a221, v253
    v_accvgpr_write_b32 a222, v254
    v_accvgpr_write_b32 a223, v255
    s_branch B_JOIN
B_STATS:
    s_cmp_lg_u32 s4, 1
    s_cbranch_scc1 NW19
    s_cmp_lg_u32 s6, 31
    s_cbranch_scc1 NW19
    v_and_b32 v5, 31, v1
    v_lshlrev_b32 v5, 2, v5
    v_add_u32 v5, s76, v5
    s_mov_b32 s96, 0
POLL20:
    buffer_load_dword v6, v5, s[28:31], 0 offen sc1
    s_waitcnt vmcnt(0)
    v_cmp_ne_u32 vcc, s7, v6
    s_cbranch_vccz PDONE21
    s_add_u32 s96, s96, 1
    s_cmp_lt_u32 s96, 50000
    s_cbranch_scc1 POLL20
PDONE21:
    v_lshlrev_b32 v5, 7, v1
    s_lshl_b32 s79, s5, 2
    s_add_u32 s79, s79, 4734976
    v_mov_b32 v6, s7
    buffer_store_dword v6, v5, s[28:31], s79 offen sc1
NW19:
B_JOIN:
    s_cmp_lg_u32 s4, 0
    s_cbranch_scc1 NW22
    v_and_b32 v5, 7, v1
    v_lshlrev_b32 v5, 2, v5
    s_and_b32 s79, s2, 63
    s_lshl_b32 s79, s79, 7
    s_add_u32 s79, s79, 4734976
    v_add_u32 v5, s79, v5
    s_mov_b32 s96, 0
POLL23:
    buffer_load_dword v6, v5, s[28:31], 0 offen sc1
    s_waitcnt vmcnt(0)
    v_cmp_ne_u32 vcc, s7, v6
    s_cbranch_vccz PDONE24
    s_add_u32 s96, s96, 1
    s_cmp_lt_u32 s96, 50000
    s_cbranch_scc1 POLL23
PDONE24:
    s_cmp_lg_u32 s2, 255
    s_cbranch_scc1 NW22
    s_mov_b32 s79, 4718592
    v_mov_b32 v6, s7
    s_mov_b64 exec, 1
    buffer_store_dword v6, off, s[28:31], s79 sc1
    s_mov_b64 exec, -1
NW22:
    s_waitcnt lgkmcnt(0)
    s_barrier
    s_cmp_ge_u32 s12, 14
    s_cbranch_scc1 P2_STATS
    v_lshlrev_b32 v9, 4, v1
    s_lshl_b32 s76, s11, 17
    s_add_u32 s76, s76, 5242880
    s_lshl_b32 s77, s4, 12
    s_add_u32 s76, s76, s77
    s_mov_b32 s80, s20
    s_lshl_b32 s79, s80, 14
    s_add_u32 s79, s79, s76
    s_mov_b32 m0, s77
    s_add_u32 s80, s80, 1
    s_and_b32 s80, s80, 3
    s_add_u32 s77, s77, 16384
    buffer_load_dwordx4 v9, s[28:31], s79 offen offset:0 sc1 lds
    buffer_load_dwordx4 v9, s[28:31], s79 offen offset:1024 sc1 lds
    buffer_load_dwordx4 v9, s[28:31], s79 offen offset:2048 sc1 lds
    buffer_load_dwordx4 v9, s[28:31], s79 offen offset:3072 sc1 lds
    s_lshl_b32 s79, s80, 14
    s_add_u32 s79, s79, s76
    s_mov_b32 m0, s77
    s_add_u32 s80, s80, 1
    s_and_b32 s80, s80, 3
    s_add_u32 s77, s77, 16384
    buffer_load_dwordx4 v9, s[28:31], s79 offen offset:0 sc1 lds
    buffer_load_dwordx4 v9, s[28:31], s79 offen offset:1024 sc1 lds
    buffer_load_dwordx4 v9, s[28:31], s79 offen offset:2048 sc1 lds
    buffer_load_dwordx4 v9, s[28:31], s79 offen offset:3072 sc1 lds
    s_lshl_b32 s79, s80, 14
    s_add_u32 s79, s79, s76
    s_mov_b32 m0, s77
    s_add_u32 s80, s80, 1
    s_and_b32 s80, s80, 3
    s_add_u32 s77, s77, 16384
    buffer_load_dwordx4 v9, s[28:31], s79 offen offset:0 sc1 lds
    buffer_load_dwordx4 v9, s[28:31], s79 offen offset:1024 sc1 lds
    buffer_load_dwordx4 v9, s[28:31], s79 offen offset:2048 sc1 lds
    buffer_load_dwordx4 v9, s[28:31], s79 offen offset:3072 sc1 lds
    s_lshl_b32 s79, s80, 14
    s_add_u32 s79, s79, s76
    s_mov_b32 m0, s77
    s_add_u32 s80, s80, 1
    s_and_b32 s80, s80, 3
    s_add_u32 s77, s77, 16384
    s_add_u32 s76, s76, 65536
    buffer_load_dwordx4 v9, s[28:31], s79 offen offset:0 sc1 lds
    buffer_load_dwordx4 v9, s[28:31], s79 offen offset:1024 sc1 lds
    buffer_load_dwordx4 v9, s[28:31], s79 offen offset:2048 sc1 lds
    buffer_load_dwordx4 v9, s[28:31], s79 offen offset:3072 sc1 lds
    v_bfe_u32 v12, v1, 2, 2
    v_and_b32 v13, 3, v1
    v_bfe_u32 v14, v1, 4, 1
    v_lshrrev_b32 v15, 5, v1
    v_lshlrev_b32 v11, 3, v15
    v_add_u32 v11, v11, v12
    v_lshlrev_b32 v11, 7, v11
    v_lshl_add_u32 v11, v14, 5, v11
    v_lshl_add_u32 v11, v13, 3, v11
    v_lshrrev_b32 v13, 1, v12
    v_lshl_add_u32 v5, v13, 6, v11
    v_xor_b32 v6, 64, v5
    v_add_u32 v7, 0x10000, v5
    v_add_u32 v8, 0x10000, v6
    v_and_b32 v12, 31, v1
    v_lshlrev_b32 v11, 3, v12
    s_and_b32 s81, s11, 1
    s_lshl_b32 s82, s81, 9
    s_add_u32 s82, s82, s3
    s_add_u32 s82, s82, 1024
    s_lshl_b32 s83, s13, 2
    s_add_u32 s82, s82, s83
    s_lshl_b32 s81, s81, 10
    s_add_u32 s81, s81, s3
    s_add_u32 s81, s81, 2048
    v_lshlrev_b32 v12, 2, v12
    v_add_u32 v12, s78, v12
    ds_write_b32 v12, v10
    v_lshlrev_b32 v0, 4, v15
    v_add_u32 v0, s78, v0
    s_lshl_b32 s83, s13, 11
    s_add_u32 s83, s83, 12582912
    s_mul_i32 s84, s11, 458752
    s_add_u32 s83, s83, s84
    s_add_u32 s84, s83, 114688
    s_add_u32 s85, s83, 229376
    s_add_u32 s86, s83, 344064
    s_lshl_b32 s87, s4, 14
    s_waitcnt lgkmcnt(0)
    ds_read_b128 v[40:43], v0 offset:0
    ds_read_b128 v[44:47], v0 offset:32
    ds_read_b128 v[48:51], v0 offset:64
    ds_read_b128 v[52:55], v0 offset:96
    s_waitcnt vmcnt(12) lgkmcnt(0)
    s_barrier
    ds_read_b64_tr_b16 v[16:17], v5 offset:0
    ds_read_b64_tr_b16 v[18:19], v5 offset:512
    ds_read_b64_tr_b16 v[20:21], v6 offset:0
    ds_read_b64_tr_b16 v[22:23], v6 offset:512
    ds_read_b64_tr_b16 v[24:25], v5 offset:2048
    ds_read_b64_tr_b16 v[26:27], v5 offset:2560
    ds_read_b64_tr_b16 v[28:29], v6 offset:2048
    ds_read_b64_tr_b16 v[30:31], v6 offset:2560
    s_waitcnt lgkmcnt(4)
    s_lshl_b32 s79, s80, 14
    s_add_u32 s79, s79, s76
    s_mov_b32 m0, s77
    s_add_u32 s80, s80, 1
    s_and_b32 s80, s80, 3
    s_add_u32 s77, s77, 16384
    v_mfma_f32_32x32x16_bf16 v[64:79], v[128:131], v[16:19], 0
    ds_read_b64_tr_b16 v[32:33], v5 offset:4096
    ds_read_b64_tr_b16 v[34:35], v5 offset:4608
    buffer_load_dwordx4 v9, s[28:31], s79 offen offset:0 sc1 lds
    v_mfma_f32_32x32x16_bf16 v[80:95], v[128:131], v[20:23], 0
    ds_read_b64_tr_b16 v[36:37], v6 offset:4096
    ds_read_b64_tr_b16 v[38:39], v6 offset:4608
    buffer_load_dwordx4 v9, s[28:31], s79 offen offset:1024 sc1 lds
    buffer_load_dwordx4 v9, s[28:31], s79 offen offset:2048 sc1 lds
    buffer_load_dwordx4 v9, s[28:31], s79 offen offset:3072 sc1 lds
    s_waitcnt lgkmcnt(4)
    v_mfma_f32_32x32x16_bf16 v[64:79], v[132:135], v[24:27], v[64:79]
    ds_read_b64_tr_b16 v[16:17], v5 offset:6144
    ds_read_b64_tr_b16 v[18:19], v5 offset:6656
    v_mfma_f32_32x32x16_bf16 v[80:95], v[132:135], v[28:31], v[80:95]
    ds_read_b64_tr_b16 v[20:21], v6 offset:6144
    ds_read_b64_tr_b16 v[22:23], v6 offset:6656
    s_waitcnt lgkmcnt(4)
    v_mfma_f32_32x32x16_bf16 v[64:79], v[136:139], v[32:35], v[64:79]
    ds_read_b64_tr_b16 v[24:25], v5 offset:8192
    ds_read_b64_tr_b16 v[26:27], v5 offset:8704
    v_mfma_f32_32x32x16_bf16 v[80:95], v[136:139], v[36:39], v[80:95]
    ds_read_b64_tr_b16 v[28:29], v6 offset:8192
    ds_read_b64_tr_b16 v[30:31], v6 offset:8704
    s_waitcnt lgkmcnt(4)
    v_mfma_f32_32x32x16_bf16 v[64:79], v[140:143], v[16:19], v[64:79]
    ds_read_b64_tr_b16 v[32:33], v5 offset:10240
    ds_read_b64_tr_b16 v[34:35], v5 offset:10752
    v_mfma_f32_32x32x16_bf16 v[80:95], v[140:143], v[20:23], v[80:95]
    ds_read_b64_tr_b16 v[36:37], v6 offset:10240
    ds_read_b64_tr_b16 v[38:39], v6 offset:10752
    s_waitcnt lgkmcnt(4)
    v_mfma_f32_32x32x16_bf16 v[64:79], v[144:147], v[24:27], v[64:79]
    ds_read_b64_tr_b16 v[16:17], v5 offset:12288
    ds_read_b64_tr_b16 v[18:19], v5 offset:12800
    v_mfma_f32_32x32x16_bf16 v[80:95], v[144:147], v[28:31], v[80:95]
    ds_read_b64_tr_b16 v[20:21], v6 offset:12288
    ds_read_b64_tr_b16 v[22:23], v6 offset:12800
    s_waitcnt lgkmcnt(4)
    v_mfma_f32_32x32x16_bf16 v[64:79], v[148:151], v[32:35], v[64:79]
    ds_read_b64_tr_b16 v[24:25], v5 offset:14336
    ds_read_b64_tr_b16 v[26:27], v5 offset:14848
    v_mfma_f32_32x32x16_bf16 v[80:95], v[148:151], v[36:39], v[80:95]
    ds_read_b64_tr_b16 v[28:29], v6 offset:14336
    ds_read_b64_tr_b16 v[30:31], v6 offset:14848
    s_waitcnt lgkmcnt(4)
    s_waitcnt vmcnt(12)
    s_barrier
    v_mfma_f32_32x32x16_bf16 v[64:79], v[152:155], v[16:19], v[64:79]
    ds_read_b64_tr_b16 v[32:33], v5 offset:16384
    ds_read_b64_tr_b16 v[34:35], v5 offset:16896
    v_mfma_f32_32x32x16_bf16 v[80:95], v[152:155], v[20:23], v[80:95]
    ds_read_b64_tr_b16 v[36:37], v6 offset:16384
    ds_read_b64_tr_b16 v[38:39], v6 offset:16896
    s_waitcnt lgkmcnt(4)
    v_mfma_f32_32x32x16_bf16 v[64:79], v[156:159], v[24:27], v[64:79]
    ds_read_b64_tr_b16 v[16:17], v5 offset:18432
    ds_read_b64_tr_b16 v[18:19], v5 offset:18944
    v_mfma_f32_32x32x16_bf16 v[80:95], v[156:159], v[28:31], v[80:95]
    ds_read_b64_tr_b16 v[20:21], v6 offset:18432
    ds_read_b64_tr_b16 v[22:23], v6 offset:18944
    s_waitcnt lgkmcnt(4)
    s_lshl_b32 s79, s80, 14
    s_add_u32 s79, s79, s76
    s_mov_b32 m0, s77
    s_add_u32 s80, s80, 1
    s_and_b32 s80, s80, 3
    s_add_u32 s77, s77, 16384
    v_mfma_f32_32x32x16_bf16 v[64:79], v[160:163], v[32:35], v[64:79]
    ds_read_b64_tr_b16 v[24:25], v5 offset:20480
    ds_read_b64_tr_b16 v[26:27], v5 offset:20992
    buffer_load_dwordx4 v9, s[28:31], s79 offen offset:0 sc1 lds
    v_mfma_f32_32x32x16_bf16 v[80:95], v[160:163], v[36:39], v[80:95]
    ds_read_b64_tr_b16 v[28:29], v6 offset:20480
    ds_read_b64_tr_b16 v[30:31], v6 offset:20992
    buffer_load_dwordx4 v9, s[28:31], s79 offen offset:1024 sc1 lds
    buffer_load_dwordx4 v9, s[28:31], s79 offen offset:2048 sc1 lds
    buffer_load_dwordx4 v9, s[28:31], s79 offen offset:3072 sc1 lds
    s_waitcnt lgkmcnt(4)
    v_mfma_f32_32x32x16_bf16 v[64:79], v[164:167], v[16:19], v[64:79]
    ds_read_b64_tr_b16 v[32:33], v5 offset:22528
    ds_read_b64_tr_b16 v[34:35], v5 offset:23040
    v_mfma_f32_32x32x16_bf16 v[80:95], v[164:167], v[20:23], v[80:95]
    ds_read_b64_tr_b16 v[36:37], v6 offset:22528
    ds_read_b64_tr_b16 v[38:39], v6 offset:23040
    s_waitcnt lgkmcnt(4)
    v_mfma_f32_32x32x16_bf16 v[64:79], v[168:171], v[24:27], v[64:79]
    ds_read_b64_tr_b16 v[16:17], v5 offset:24576
    ds_read_b64_tr_b16 v[18:19], v5 offset:25088
    v_mfma_f32_32x32x16_bf16 v[80:95], v[168:171], v[28:31], v[80:95]
    ds_read_b64_tr_b16 v[20:21], v6 offset:24576
    ds_read_b64_tr_b16 v[22:23], v6 offset:25088
    s_waitcnt lgkmcnt(4)
    v_mfma_f32_32x32x16_bf16 v[64:79], v[172:175], v[32:35], v[64:79]
    ds_read_b64_tr_b16 v[24:25], v5 offset:26624
    ds_read_b64_tr_b16 v[26:27], v5 offset:27136
    v_mfma_f32_32x32x16_bf16 v[80:95], v[172:175], v[36:39], v[80:95]
    ds_read_b64_tr_b16 v[28:29], v6 offset:26624
    ds_read_b64_tr_b16 v[30:31], v6 offset:27136
    s_waitcnt lgkmcnt(4)
    v_mfma_f32_32x32x16_bf16 v[64:79], v[176:179], v[16:19], v[64:79]
    ds_read_b64_tr_b16 v[32:33], v5 offset:28672
    ds_read_b64_tr_b16 v[34:35], v5 offset:29184
    v_mfma_f32_32x32x16_bf16 v[80:95], v[176:179], v[20:23], v[80:95]
    ds_read_b64_tr_b16 v[36:37], v6 offset:28672
    ds_read_b64_tr_b16 v[38:39], v6 offset:29184
    s_waitcnt lgkmcnt(4)
    v_mfma_f32_32x32x16_bf16 v[64:79], v[180:183], v[24:27], v[64:79]
    ds_read_b64_tr_b16 v[16:17], v5 offset:30720
    ds_read_b64_tr_b16 v[18:19], v5 offset:31232
    v_mfma_f32_32x32x16_bf16 v[80:95], v[180:183], v[28:31], v[80:95]
    ds_read_b64_tr_b16 v[20:21], v6 offset:30720
    ds_read_b64_tr_b16 v[22:23], v6 offset:31232
    s_waitcnt lgkmcnt(4)
    s_waitcnt vmcnt(12)
    s_barrier
    v_mfma_f32_32x32x16_bf16 v[64:79], v[184:187], v[32:35], v[64:79]
    ds_read_b64_tr_b16 v[24:25], v5 offset:32768
    ds_read_b64_tr_b16 v[26:27], v5 offset:33280
    v_mfma_f32_32x32x16_bf16 v[80:95], v[184:187], v[36:39], v[80:95]
    ds_read_b64_tr_b16 v[28:29], v6 offset:32768
    ds_read_b64_tr_b16 v[30:31], v6 offset:33280
    s_waitcnt lgkmcnt(4)
    v_mfma_f32_32x32x16_bf16 v[64:79], v[188:191], v[16:19], v[64:79]
    ds_read_b64_tr_b16 v[32:33], v5 offset:34816
    ds_read_b64_tr_b16 v[34:35], v5 offset:35328
    v_mfma_f32_32x32x16_bf16 v[80:95], v[188:191], v[20:23], v[80:95]
    ds_read_b64_tr_b16 v[36:37], v6 offset:34816
    ds_read_b64_tr_b16 v[38:39], v6 offset:35328
    s_waitcnt lgkmcnt(4)
    s_lshl_b32 s79, s80, 14
    s_add_u32 s79, s79, s76
    s_mov_b32 m0, s77
    s_add_u32 s80, s80, 1
    s_and_b32 s80, s80, 3
    s_add_u32 s77, s77, 16384
    v_mfma_f32_32x32x16_bf16 v[64:79], a[160:163], v[24:27], v[64:79]
    ds_read_b64_tr_b16 v[16:17], v5 offset:36864
    ds_read_b64_tr_b16 v[18:19], v5 offset:37376
    buffer_load_dwordx4 v9, s[28:31], s79 offen offset:0 sc1 lds
    v_mfma_f32_32x32x16_bf16 v[80:95], a[160:163], v[28:31], v[80:95]
    ds_read_b64_tr_b16 v[20:21], v6 offset:36864
    ds_read_b64_tr_b16 v[22:23], v6 offset:37376
    buffer_load_dwordx4 v9, s[28:31], s79 offen offset:1024 sc1 lds
    buffer_load_dwordx4 v9, s[28:31], s79 offen offset:2048 sc1 lds
    buffer_load_dwordx4 v9, s[28:31], s79 offen offset:3072 sc1 lds
    s_waitcnt lgkmcnt(4)
    v_mfma_f32_32x32x16_bf16 v[64:79], a[164:167], v[32:35], v[64:79]
    ds_read_b64_tr_b16 v[24:25], v5 offset:38912
    ds_read_b64_tr_b16 v[26:27], v5 offset:39424
    v_mfma_f32_32x32x16_bf16 v[80:95], a[164:167], v[36:39], v[80:95]
    ds_read_b64_tr_b16 v[28:29], v6 offset:38912
    ds_read_b64_tr_b16 v[30:31], v6 offset:39424
    s_waitcnt lgkmcnt(4)
    v_mfma_f32_32x32x16_bf16 v[64:79], a[168:171], v[16:19], v[64:79]
    ds_read_b64_tr_b16 v[32:33], v5 offset:40960
    ds_read_b64_tr_b16 v[34:35], v5 offset:41472
    v_mfma_f32_32x32x16_bf16 v[80:95], a[168:171], v[20:23], v[80:95]
    ds_read_b64_tr_b16 v[36:37], v6 offset:40960
    ds_read_b64_tr_b16 v[38:39], v6 offset:41472
    s_waitcnt lgkmcnt(4)
    v_mfma_f32_32x32x16_bf16 v[64:79], a[172:175], v[24:27], v[64:79]
    ds_read_b64_tr_b16 v[16:17], v5 offset:43008
    ds_read_b64_tr_b16 v[18:19], v5 offset:43520
    v_mfma_f32_32x32x16_bf16 v[80:95], a[172:175], v[28:31], v[80:95]
    ds_read_b64_tr_b16 v[20:21], v6 offset:43008
    ds_read_b64_tr_b16 v[22:23], v6 offset:43520
    s_waitcnt lgkmcnt(4)
    v_mfma_f32_32x32x16_bf16 v[64:79], a[176:179], v[32:35], v[64:79]
    ds_read_b64_tr_b16 v[24:25], v5 offset:45056
    ds_read_b64_tr_b16 v[26:27], v5 offset:45568
    v_mfma_f32_32x32x16_bf16 v[80:95], a[176:179], v[36:39], v[80:95]
    ds_read_b64_tr_b16 v[28:29], v6 offset:45056
    ds_read_b64_tr_b16 v[30:31], v6 offset:45568
    s_waitcnt lgkmcnt(4)
    v_mfma_f32_32x32x16_bf16 v[64:79], a[180:183], v[16:19], v[64:79]
    ds_read_b64_tr_b16 v[32:33], v5 offset:47104
    ds_read_b64_tr_b16 v[34:35], v5 offset:47616
    v_mfma_f32_32x32x16_bf16 v[80:95], a[180:183], v[20:23], v[80:95]
    ds_read_b64_tr_b16 v[36:37], v6 offset:47104
    ds_read_b64_tr_b16 v[38:39], v6 offset:47616
    s_waitcnt lgkmcnt(4)
    s_waitcnt vmcnt(12)
    s_barrier
    v_mfma_f32_32x32x16_bf16 v[64:79], a[184:187], v[24:27], v[64:79]
    ds_read_b64_tr_b16 v[16:17], v5 offset:49152
    ds_read_b64_tr_b16 v[18:19], v5 offset:49664
    v_mfma_f32_32x32x16_bf16 v[80:95], a[184:187], v[28:31], v[80:95]
    ds_read_b64_tr_b16 v[20:21], v6 offset:49152
    ds_read_b64_tr_b16 v[22:23], v6 offset:49664
    s_waitcnt lgkmcnt(4)
    v_mfma_f32_32x32x16_bf16 v[64:79], a[188:191], v[32:35], v[64:79]
    ds_read_b64_tr_b16 v[24:25], v5 offset:51200
    ds_read_b64_tr_b16 v[26:27], v5 offset:51712
    v_mfma_f32_32x32x16_bf16 v[80:95], a[188:191], v[36:39], v[80:95]
    ds_read_b64_tr_b16 v[28:29], v6 offset:51200
    ds_read_b64_tr_b16 v[30:31], v6 offset:51712
    s_waitcnt lgkmcnt(4)
    s_lshl_b32 s79, s80, 14
    s_add_u32 s79, s79, s76
    s_mov_b32 m0, s77
    s_add_u32 s80, s80, 1
    s_and_b32 s80, s80, 3
    s_add_u32 s77, s77, 16384
    s_mul_i32 s88, s4, 56
    s_add_u32 s88, s88, 224
    v_min_u32 v12, 55, v1
    s_lshl_b32 s97, s23, 6
    s_add_u32 s97, s97, s88
    v_add_u32 v12, s97, v12
    v_subrev_u32 v13, 448, v12
    v_min_u32 v12, v12, v13
    v_lshlrev_b32 v12, 10, v12
    s_and_b32 s97, s6, 3
    s_mul_i32 s97, s97, 458752
    s_lshl_b32 s94, s15, 7
    s_add_u32 s97, s97, s94
    buffer_load_dword v13, v12, s[60:63], s97 offen sc1
    v_mfma_f32_32x32x16_bf16 v[64:79], a[192:195], v[16:19], v[64:79]
    ds_read_b64_tr_b16 v[32:33], v5 offset:53248
    ds_read_b64_tr_b16 v[34:35], v5 offset:53760
    buffer_load_dwordx4 v9, s[28:31], s79 offen offset:0 sc1 lds
    v_mfma_f32_32x32x16_bf16 v[80:95], a[192:195], v[20:23], v[80:95]
    ds_read_b64_tr_b16 v[36:37], v6 offset:53248
    ds_read_b64_tr_b16 v[38:39], v6 offset:53760
    buffer_load_dwordx4 v9, s[28:31], s79 offen offset:1024 sc1 lds
    buffer_load_dwordx4 v9, s[28:31], s79 offen offset:2048 sc1 lds
    buffer_load_dwordx4 v9, s[28:31], s79 offen offset:3072 sc1 lds
    s_waitcnt lgkmcnt(4)
    v_mfma_f32_32x32x16_bf16 v[64:79], a[196:199], v[24:27], v[64:79]
    ds_read_b64_tr_b16 v[16:17], v5 offset:55296
    ds_read_b64_tr_b16 v[18:19], v5 offset:55808
    v_mfma_f32_32x32x16_bf16 v[80:95], a[196:199], v[28:31], v[80:95]
    ds_read_b64_tr_b16 v[20:21], v6 offset:55296
    ds_read_b64_tr_b16 v[22:23], v6 offset:55808
    s_waitcnt lgkmcnt(4)
    buffer_load_dwordx2 v[240:241], v11, s[28:31], s81 offen offset:0 sc1
    buffer_load_dwordx2 v[242:243], v11, s[28:31], s81 offen offset:256 sc1
    v_mfma_f32_32x32x16_bf16 v[64:79], a[200:203], v[32:35], v[64:79]
    ds_read_b64_tr_b16 v[24:25], v5 offset:57344
    ds_read_b64_tr_b16 v[26:27], v5 offset:57856
    v_mfma_f32_32x32x16_bf16 v[80:95], a[200:203], v[36:39], v[80:95]
    ds_read_b64_tr_b16 v[28:29], v6 offset:57344
    ds_read_b64_tr_b16 v[30:31], v6 offset:57856
    s_waitcnt lgkmcnt(4)
    v_mfma_f32_32x32x16_bf16 v[64:79], a[204:207], v[16:19], v[64:79]
    ds_read_b64_tr_b16 v[32:33], v5 offset:59392
    ds_read_b64_tr_b16 v[34:35], v5 offset:59904
    v_mfma_f32_32x32x16_bf16 v[80:95], a[204:207], v[20:23], v[80:95]
    ds_read_b64_tr_b16 v[36:37], v6 offset:59392
    ds_read_b64_tr_b16 v[38:39], v6 offset:59904
    s_waitcnt lgkmcnt(4)
    v_mfma_f32_32x32x16_bf16 v[64:79], a[208:211], v[24:27], v[64:79]
    ds_read_b64_tr_b16 v[16:17], v5 offset:61440
    ds_read_b64_tr_b16 v[18:19], v5 offset:61952
    v_mfma_f32_32x32x16_bf16 v[80:95], a[208:211], v[28:31], v[80:95]
    ds_read_b64_tr_b16 v[20:21], v6 offset:61440
    ds_read_b64_tr_b16 v[22:23], v6 offset:61952
    s_waitcnt lgkmcnt(4)
    v_mfma_f32_32x32x16_bf16 v[64:79], a[212:215], v[32:35], v[64:79]
    ds_read_b64_tr_b16 v[24:25], v5 offset:63488
    ds_read_b64_tr_b16 v[26:27], v5 offset:64000
    v_mfma_f32_32x32x16_bf16 v[80:95], a[212:215], v[36:39], v[80:95]
    ds_read_b64_tr_b16 v[28:29], v6 offset:63488
    ds_read_b64_tr_b16 v[30:31], v6 offset:64000
    s_waitcnt lgkmcnt(4)
    s_waitcnt vmcnt(15)
    s_barrier
    v_mfma_f32_32x32x16_bf16 v[64:79], a[216:219], v[16:19], v[64:79]
    ds_read_b64_tr_b16 v[32:33], v7 offset:0
    ds_read_b64_tr_b16 v[34:35], v7 offset:512
    v_mfma_f32_32x32x16_bf16 v[80:95], a[216:219], v[20:23], v[80:95]
    ds_read_b64_tr_b16 v[36:37], v8 offset:0
    ds_read_b64_tr_b16 v[38:39], v8 offset:512
    s_waitcnt lgkmcnt(4)
    v_mfma_f32_32x32x16_bf16 v[64:79], a[220:223], v[24:27], v[64:79]
    ds_read_b64_tr_b16 v[16:17], v7 offset:2048
    ds_read_b64_tr_b16 v[18:19], v7 offset:2560
    v_mfma_f32_32x32x16_bf16 v[80:95], a[220:223], v[28:31], v[80:95]
    ds_read_b64_tr_b16 v[20:21], v8 offset:2048
    ds_read_b64_tr_b16 v[22:23], v8 offset:2560
    s_waitcnt lgkmcnt(4)
    v_mfma_f32_32x32x16_bf16 v[96:111], v[128:131], v[32:35], 0
    ds_read_b64_tr_b16 v[24:25], v7 offset:4096
    ds_read_b64_tr_b16 v[26:27], v7 offset:4608
    v_mfma_f32_32x32x16_bf16 v[112:127], v[128:131], v[36:39], 0
    ds_read_b64_tr_b16 v[28:29], v8 offset:4096
    ds_read_b64_tr_b16 v[30:31], v8 offset:4608
    s_waitcnt lgkmcnt(4)
    v_mfma_f32_32x32x16_bf16 v[96:111], v[132:135], v[16:19], v[96:111]
    ds_read_b64_tr_b16 v[32:33], v7 offset:6144
    ds_read_b64_tr_b16 v[34:35], v7 offset:6656
    v_mfma_f32_32x32x16_bf16 v[112:127], v[132:135], v[20:23], v[112:127]
    ds_read_b64_tr_b16 v[36:37], v8 offset:6144
    ds_read_b64_tr_b16 v[38:39], v8 offset:6656
    s_waitcnt lgkmcnt(4)
    s_waitcnt vmcnt(0)
    s_mov_b32 s96, 0
HSRE26:
    v_xor_b32 v12, s7, v241
    v_xor_b32 v13, s7, v243
    v_or_b32 v12, v12, v13
    v_cmp_ne_u32 vcc, 0, v12
    s_cbranch_vccz HSOK25
    s_add_u32 s96, s96, 1
    s_cmp_ge_u32 s96, 50000
    s_cbranch_scc1 HSOK25
    buffer_load_dwordx2 v[240:241], v11, s[28:31], s81 offen offset:0 sc1
    buffer_load_dwordx2 v[242:243], v11, s[28:31], s81 offen offset:256 sc1
    s_waitcnt vmcnt(0)
    s_branch HSRE26
HSOK25:
    v_and_b32 v58, 0xffff0000, v240
    v_lshlrev_b32 v56, 16, v240
    v_rcp_f32 v57, v58
    v_xor_b32 v56, 0x80000000, v56
    v_mul_f32 v57, 0xbfb8aa3b, v57
    v_and_b32 v62, 0xffff0000, v242
    v_lshlrev_b32 v60, 16, v242
    v_rcp_f32 v61, v62
    v_xor_b32 v60, 0x80000000, v60
    v_mul_f32 v61, 0xbfb8aa3b, v61
    v_mfma_f32_32x32x16_bf16 v[96:111], v[136:139], v[24:27], v[96:111]
    ds_read_b64_tr_b16 v[16:17], v7 offset:8192
    ds_read_b64_tr_b16 v[18:19], v7 offset:8704
    v_fmac_f32 v64, v40, v56
    v_fmac_f32 v65, v41, v56
    v_fmac_f32 v66, v42, v56
    v_fmac_f32 v67, v43, v56
    v_mfma_f32_32x32x16_bf16 v[112:127], v[136:139], v[28:31], v[112:127]
    ds_read_b64_tr_b16 v[20:21], v8 offset:8192
    ds_read_b64_tr_b16 v[22:23], v8 offset:8704
    v_fmac_f32 v68, v44, v56
    v_fmac_f32 v69, v45, v56
    v_fmac_f32 v70, v46, v56
    v_fmac_f32 v71, v47, v56
    s_waitcnt lgkmcnt(4)
    v_mfma_f32_32x32x16_bf16 v[96:111], v[140:143], v[32:35], v[96:111]
    ds_read_b64_tr_b16 v[24:25], v7 offset:10240
    ds_read_b64_tr_b16 v[26:27], v7 offset:10752
    v_mul_f32 v192, v64, v57
    v_mul_f32 v193, v65, v57
    v_mul_f32 v194, v66, v57
    v_mul_f32 v195, v67, v57
    v_mfma_f32_32x32x16_bf16 v[112:127], v[140:143], v[36:39], v[112:127]
    ds_read_b64_tr_b16 v[28:29], v8 offset:10240
    ds_read_b64_tr_b16 v[30:31], v8 offset:10752
    v_mul_f32 v196, v68, v57
    v_mul_f32 v197, v69, v57
    v_mul_f32 v198, v70, v57
    v_mul_f32 v199, v71, v57
    s_waitcnt lgkmcnt(4)
    v_mfma_f32_32x32x16_bf16 v[96:111], v[144:147], v[16:19], v[96:111]
    ds_read_b64_tr_b16 v[32:33], v7 offset:12288
    ds_read_b64_tr_b16 v[34:35], v7 offset:12800
    v_exp_f32 v192, v192
    v_exp_f32 v193, v193
    v_exp_f32 v194, v194
    v_exp_f32 v195, v195
    v_mfma_f32_32x32x16_bf16 v[112:127], v[144:147], v[20:23], v[112:127]
    ds_read_b64_tr_b16 v[36:37], v8 offset:12288
    ds_read_b64_tr_b16 v[38:39], v8 offset:12800
    v_exp_f32 v196, v196
    v_exp_f32 v197, v197
    v_exp_f32 v198, v198
    v_exp_f32 v199, v199
    s_waitcnt lgkmcnt(4)
    v_mfma_f32_32x32x16_bf16 v[96:111], v[148:151], v[24:27], v[96:111]
    ds_read_b64_tr_b16 v[16:17], v7 offset:14336
    ds_read_b64_tr_b16 v[18:19], v7 offset:14848
    v_fma_f32 v192, v192, v58, v58
    v_fma_f32 v193, v193, v58, v58
    v_fma_f32 v194, v194, v58, v58
    v_fma_f32 v195, v195, v58, v58
    v_mfma_f32_32x32x16_bf16 v[112:127], v[148:151], v[28:31], v[112:127]
    ds_read_b64_tr_b16 v[20:21], v8 offset:14336
    ds_read_b64_tr_b16 v[22:23], v8 offset:14848
    v_fma_f32 v196, v196, v58, v58
    v_fma_f32 v197, v197, v58, v58
    v_fma_f32 v198, v198, v58, v58
    v_fma_f32 v199, v199, v58, v58
    s_waitcnt lgkmcnt(4)
    s_barrier
    v_mfma_f32_32x32x16_bf16 v[96:111], v[152:155], v[32:35], v[96:111]
    ds_read_b64_tr_b16 v[24:25], v7 offset:16384
    ds_read_b64_tr_b16 v[26:27], v7 offset:16896
    v_rcp_f32 v192, v192
    v_rcp_f32 v193, v193
    v_rcp_f32 v194, v194
    v_rcp_f32 v195, v195
    v_mfma_f32_32x32x16_bf16 v[112:127], v[152:155], v[36:39], v[112:127]
    ds_read_b64_tr_b16 v[28:29], v8 offset:16384
    ds_read_b64_tr_b16 v[30:31], v8 offset:16896
    v_rcp_f32 v196, v196
    v_rcp_f32 v197, v197
    v_rcp_f32 v198, v198
    v_rcp_f32 v199, v199
    s_waitcnt lgkmcnt(4)
    v_mfma_f32_32x32x16_bf16 v[96:111], v[156:159], v[16:19], v[96:111]
    ds_read_b64_tr_b16 v[32:33], v7 offset:18432
    ds_read_b64_tr_b16 v[34:35], v7 offset:18944
    v_mul_f32 v192, v192, v64
    v_mul_f32 v193, v193, v65
    v_mul_f32 v194, v194, v66
    v_mul_f32 v195, v195, v67
    v_mfma_f32_32x32x16_bf16 v[112:127], v[156:159], v[20:23], v[112:127]
    ds_read_b64_tr_b16 v[36:37], v8 offset:18432
    ds_read_b64_tr_b16 v[38:39], v8 offset:18944
    v_mul_f32 v196, v196, v68
    v_mul_f32 v197, v197, v69
    v_mul_f32 v198, v198, v70
    v_mul_f32 v199, v199, v71
    s_waitcnt lgkmcnt(4)
    v_mfma_f32_32x32x16_bf16 v[96:111], v[160:163], v[24:27], v[96:111]
    ds_read_b64_tr_b16 v[16:17], v7 offset:20480
    ds_read_b64_tr_b16 v[18:19], v7 offset:20992
    s_mov_b32 m0, s87
    s_nop 0
    buffer_load_dwordx4 v2, s[60:63], s18 offen lds
    s_add_u32 s18, s18, 8192
    s_add_u32 m0, m0, 1024
    s_cmp_eq_u32 s18, s22
    s_cselect_b32 s97, 458752, 0
    s_sub_u32 s18, s18, s97
    v_cvt_pk_bf16_f32 v224, v192, v193
    v_cvt_pk_bf16_f32 v225, v194, v195
    v_cvt_pk_bf16_f32 v226, v196, v197
    v_cvt_pk_bf16_f32 v227, v198, v199
    v_mfma_f32_32x32x16_bf16 v[112:127], v[160:163], v[28:31], v[112:127]
    ds_read_b64_tr_b16 v[20:21], v8 offset:20480
    ds_read_b64_tr_b16 v[22:23], v8 offset:20992
    buffer_store_dwordx4 v[224:227], v9, s[28:31], s83 offen offset:0 sc1
    v_fmac_f32 v72, v48, v56
    v_fmac_f32 v73, v49, v56
    v_fmac_f32 v74, v50, v56
    s_waitcnt lgkmcnt(4)
    v_mfma_f32_32x32x16_bf16 v[96:111], v[164:167], v[32:35], v[96:111]
    ds_read_b64_tr_b16 v[24:25], v7 offset:22528
    ds_read_b64_tr_b16 v[26:27], v7 offset:23040
    buffer_load_dwordx4 v2, s[60:63], s18 offen lds
    s_add_u32 s18, s18, 8192
    s_add_u32 m0, m0, 1024
    s_cmp_eq_u32 s18, s22
    s_cselect_b32 s97, 458752, 0
    s_sub_u32 s18, s18, s97
    v_fmac_f32 v75, v51, v56
    v_fmac_f32 v76, v52, v56
    v_fmac_f32 v77, v53, v56
    v_fmac_f32 v78, v54, v56
    v_mfma_f32_32x32x16_bf16 v[112:127], v[164:167], v[36:39], v[112:127]
    ds_read_b64_tr_b16 v[28:29], v8 offset:22528
    ds_read_b64_tr_b16 v[30:31], v8 offset:23040
    v_fmac_f32 v79, v55, v56
    v_mul_f32 v200, v72, v57
    v_mul_f32 v201, v73, v57
    v_mul_f32 v202, v74, v57
    s_waitcnt lgkmcnt(4)
    v_mfma_f32_32x32x16_bf16 v[96:111], v[168:171], v[16:19], v[96:111]
    ds_read_b64_tr_b16 v[32:33], v7 offset:24576
    ds_read_b64_tr_b16 v[34:35], v7 offset:25088
    buffer_load_dwordx4 v2, s[60:63], s18 offen lds
    s_add_u32 s18, s18, 8192
    s_add_u32 m0, m0, 1024
    s_cmp_eq_u32 s18, s22
    s_cselect_b32 s97, 458752, 0
    s_sub_u32 s18, s18, s97
    v_mul_f32 v203, v75, v57
    v_mul_f32 v204, v76, v57
    v_mul_f32 v205, v77, v57
    v_mul_f32 v206, v78, v57
    v_mfma_f32_32x32x16_bf16 v[112:127], v[168:171], v[20:23], v[112:127]
    ds_read_b64_tr_b16 v[36:37], v8 offset:24576
    ds_read_b64_tr_b16 v[38:39], v8 offset:25088
    v_mul_f32 v207, v79, v57
    v_exp_f32 v200, v200
    v_exp_f32 v201, v201
    v_exp_f32 v202, v202
    s_waitcnt lgkmcnt(4)
    v_mfma_f32_32x32x16_bf16 v[96:111], v[172:175], v[24:27], v[96:111]
    ds_read_b64_tr_b16 v[16:17], v7 offset:26624
    ds_read_b64_tr_b16 v[18:19], v7 offset:27136
    buffer_load_dwordx4 v2, s[60:63], s18 offen lds
    s_add_u32 s18, s18, 8192
    s_add_u32 m0, m0, 1024
    s_cmp_eq_u32 s18, s22
    s_cselect_b32 s97, 458752, 0
    s_sub_u32 s18, s18, s97
    v_exp_f32 v203, v203
    v_exp_f32 v204, v204
    v_exp_f32 v205, v205
    v_exp_f32 v206, v206
    v_mfma_f32_32x32x16_bf16 v[112:127], v[172:175], v[28:31], v[112:127]
    ds_read_b64_tr_b16 v[20:21], v8 offset:26624
    ds_read_b64_tr_b16 v[22:23], v8 offset:27136
    v_exp_f32 v207, v207
    v_fma_f32 v200, v200, v58, v58
    v_fma_f32 v201, v201, v58, v58
    v_fma_f32 v202, v202, v58, v58
    s_waitcnt lgkmcnt(4)
    v_mfma_f32_32x32x16_bf16 v[96:111], v[176:179], v[32:35], v[96:111]
    ds_read_b64_tr_b16 v[24:25], v7 offset:28672
    ds_read_b64_tr_b16 v[26:27], v7 offset:29184
    buffer_load_dwordx4 v2, s[60:63], s18 offen lds
    s_add_u32 s18, s18, 8192
    s_add_u32 m0, m0, 1024
    s_cmp_eq_u32 s18, s22
    s_cselect_b32 s97, 458752, 0
    s_sub_u32 s18, s18, s97
    v_fma_f32 v203, v203, v58, v58
    v_fma_f32 v204, v204, v58, v58
    v_fma_f32 v205, v205, v58, v58
    v_fma_f32 v206, v206, v58, v58
    v_mfma_f32_32x32x16_bf16 v[112:127], v[176:179], v[36:39], v[112:127]
    ds_read_b64_tr_b16 v[28:29], v8 offset:28672
    ds_read_b64_tr_b16 v[30:31], v8 offset:29184
    v_fma_f32 v207, v207, v58, v58
    v_rcp_f32 v200, v200
    v_rcp_f32 v201, v201
    v_rcp_f32 v202, v202
    s_waitcnt lgkmcnt(4)
    v_mfma_f32_32x32x16_bf16 v[96:111], v[180:183], v[16:19], v[96:111]
    ds_read_b64_tr_b16 v[32:33], v7 offset:30720
    ds_read_b64_tr_b16 v[34:35], v7 offset:31232
    buffer_load_dwordx4 v2, s[60:63], s18 offen lds
    s_add_u32 s18, s18, 8192
    s_add_u32 m0, m0, 1024
    s_cmp_eq_u32 s18, s22
    s_cselect_b32 s97, 458752, 0
    s_sub_u32 s18, s18, s97
    v_rcp_f32 v203, v203
    v_rcp_f32 v204, v204
    v_rcp_f32 v205, v205
    v_rcp_f32 v206, v206
    v_mfma_f32_32x32x16_bf16 v[112:127], v[180:183], v[20:23], v[112:127]
    ds_read_b64_tr_b16 v[36:37], v8 offset:30720
    ds_read_b64_tr_b16 v[38:39], v8 offset:31232
    v_rcp_f32 v207, v207
    v_mul_f32 v200, v200, v72
    v_mul_f32 v201, v201, v73
    v_mul_f32 v202, v202, v74
    s_waitcnt lgkmcnt(4)
    s_barrier
    v_mfma_f32_32x32x16_bf16 v[96:111], v[184:187], v[24:27], v[96:111]
    ds_read_b64_tr_b16 v[16:17], v7 offset:32768
    ds_read_b64_tr_b16 v[18:19], v7 offset:33280
    buffer_load_dwordx4 v2, s[60:63], s18 offen lds
    s_add_u32 s18, s18, 8192
    s_add_u32 m0, m0, 1024
    s_cmp_eq_u32 s18, s22
    s_cselect_b32 s97, 458752, 0
    s_sub_u32 s18, s18, s97
    v_mul_f32 v203, v203, v75
    v_mul_f32 v204, v204, v76
    v_mul_f32 v205, v205, v77
    v_mul_f32 v206, v206, v78
    v_mfma_f32_32x32x16_bf16 v[112:127], v[184:187], v[28:31], v[112:127]
    ds_read_b64_tr_b16 v[20:21], v8 offset:32768
    ds_read_b64_tr_b16 v[22:23], v8 offset:33280
    v_mul_f32 v207, v207, v79
    v_cvt_pk_bf16_f32 v228, v200, v201
    v_cvt_pk_bf16_f32 v229, v202, v203
    v_cvt_pk_bf16_f32 v230, v204, v205
    s_waitcnt lgkmcnt(4)
    v_mfma_f32_32x32x16_bf16 v[96:111], v[188:191], v[32:35], v[96:111]
    ds_read_b64_tr_b16 v[24:25], v7 offset:34816
    ds_read_b64_tr_b16 v[26:27], v7 offset:35328
    buffer_load_dwordx4 v2, s[60:63], s18 offen lds
    s_add_u32 s18, s18, 8192
    s_add_u32 m0, m0, 1024
    s_cmp_eq_u32 s18, s22
    s_cselect_b32 s97, 458752, 0
    s_sub_u32 s18, s18, s97
    v_cvt_pk_bf16_f32 v231, v206, v207
    buffer_store_dwordx4 v[228:231], v9, s[28:31], s83 offen offset:1024 sc1
    v_fmac_f32 v80, v40, v60
    v_fmac_f32 v81, v41, v60
    v_mfma_f32_32x32x16_bf16 v[112:127], v[188:191], v[36:39], v[112:127]
    ds_read_b64_tr_b16 v[28:29], v8 offset:34816
    ds_read_b64_tr_b16 v[30:31], v8 offset:35328
    v_fmac_f32 v82, v42, v60
    v_fmac_f32 v83, v43, v60
    v_fmac_f32 v84, v44, v60
    v_fmac_f32 v85, v45, v60
    s_waitcnt lgkmcnt(4)
    v_mfma_f32_32x32x16_bf16 v[96:111], a[160:163], v[16:19], v[96:111]
    ds_read_b64_tr_b16 v[32:33], v7 offset:36864
    ds_read_b64_tr_b16 v[34:35], v7 offset:37376
    buffer_load_dwordx4 v2, s[60:63], s18 offen lds
    s_add_u32 s18, s18, 8192
    s_add_u32 m0, m0, 1024
    s_cmp_eq_u32 s18, s22
    s_cselect_b32 s97, 458752, 0
    s_sub_u32 s18, s18, s97
    v_fmac_f32 v86, v46, v60
    v_fmac_f32 v87, v47, v60
    v_mul_f32 v208, v80, v61
    v_mul_f32 v209, v81, v61
    v_mfma_f32_32x32x16_bf16 v[112:127], a[160:163], v[20:23], v[112:127]
    ds_read_b64_tr_b16 v[36:37], v8 offset:36864
    ds_read_b64_tr_b16 v[38:39], v8 offset:37376
    v_mul_f32 v210, v82, v61
    v_mul_f32 v211, v83, v61
    v_mul_f32 v212, v84, v61
    v_mul_f32 v213, v85, v61
    s_waitcnt lgkmcnt(4)
    v_mfma_f32_32x32x16_bf16 v[96:111], a[164:167], v[24:27], v[96:111]
    ds_read_b64_tr_b16 v[16:17], v7 offset:38912
    ds_read_b64_tr_b16 v[18:19], v7 offset:39424
    buffer_load_dwordx4 v2, s[60:63], s18 offen lds
    s_add_u32 s18, s18, 8192
    s_add_u32 m0, m0, 1024
    s_cmp_eq_u32 s18, s22
    s_cselect_b32 s97, 458752, 0
    s_sub_u32 s18, s18, s97
    v_mul_f32 v214, v86, v61
    v_mul_f32 v215, v87, v61
    v_exp_f32 v208, v208
    v_exp_f32 v209, v209
    v_mfma_f32_32x32x16_bf16 v[112:127], a[164:167], v[28:31], v[112:127]
    ds_read_b64_tr_b16 v[20:21], v8 offset:38912
    ds_read_b64_tr_b16 v[22:23], v8 offset:39424
    v_exp_f32 v210, v210
    v_exp_f32 v211, v211
    v_exp_f32 v212, v212
    v_exp_f32 v213, v213
    s_waitcnt lgkmcnt(4)
    v_mfma_f32_32x32x16_bf16 v[96:111], a[168:171], v[32:35], v[96:111]
    ds_read_b64_tr_b16 v[24:25], v7 offset:40960
    ds_read_b64_tr_b16 v[26:27], v7 offset:41472
    buffer_load_dwordx4 v2, s[60:63], s18 offen lds
    s_add_u32 s18, s18, 8192
    s_add_u32 m0, m0, 1024
    s_cmp_eq_u32 s18, s22
    s_cselect_b32 s97, 458752, 0
    s_sub_u32 s18, s18, s97
    v_exp_f32 v214, v214
    v_exp_f32 v215, v215
    v_fma_f32 v208, v208, v62, v62
    v_fma_f32 v209, v209, v62, v62
    v_mfma_f32_32x32x16_bf16 v[112:127], a[168:171], v[36:39], v[112:127]
    ds_read_b64_tr_b16 v[28:29], v8 offset:40960
    ds_read_b64_tr_b16 v[30:31], v8 offset:41472
    v_fma_f32 v210, v210, v62, v62
    v_fma_f32 v211, v211, v62, v62
    v_fma_f32 v212, v212, v62, v62
    v_fma_f32 v213, v213, v62, v62
    s_waitcnt lgkmcnt(4)
    v_mfma_f32_32x32x16_bf16 v[96:111], a[172:175], v[16:19], v[96:111]
    ds_read_b64_tr_b16 v[32:33], v7 offset:43008
    ds_read_b64_tr_b16 v[34:35], v7 offset:43520
    buffer_load_dwordx4 v2, s[60:63], s18 offen lds
    s_add_u32 s18, s18, 8192
    s_add_u32 m0, m0, 1024
    s_cmp_eq_u32 s18, s22
    s_cselect_b32 s97, 458752, 0
    s_sub_u32 s18, s18, s97
    v_fma_f32 v214, v214, v62, v62
    v_fma_f32 v215, v215, v62, v62
    v_rcp_f32 v208, v208
    v_rcp_f32 v209, v209
    v_mfma_f32_32x32x16_bf16 v[112:127], a[172:175], v[20:23], v[112:127]
    ds_read_b64_tr_b16 v[36:37], v8 offset:43008
    ds_read_b64_tr_b16 v[38:39], v8 offset:43520
    v_rcp_f32 v210, v210
    v_rcp_f32 v211, v211
    v_rcp_f32 v212, v212
    v_rcp_f32 v213, v213
    s_waitcnt lgkmcnt(4)
    v_mfma_f32_32x32x16_bf16 v[96:111], a[176:179], v[24:27], v[96:111]
    ds_read_b64_tr_b16 v[16:17], v7 offset:45056
    ds_read_b64_tr_b16 v[18:19], v7 offset:45568
    v_rcp_f32 v214, v214
    v_rcp_f32 v215, v215
    v_mul_f32 v208, v208, v80
    v_mul_f32 v209, v209, v81
    v_mfma_f32_32x32x16_bf16 v[112:127], a[176:179], v[28:31], v[112:127]
    ds_read_b64_tr_b16 v[20:21], v8 offset:45056
    ds_read_b64_tr_b16 v[22:23], v8 offset:45568
    v_mul_f32 v210, v210, v82
    v_mul_f32 v211, v211, v83
    v_mul_f32 v212, v212, v84
    v_mul_f32 v213, v213, v85
    s_waitcnt lgkmcnt(4)
    v_mfma_f32_32x32x16_bf16 v[96:111], a[180:183], v[32:35], v[96:111]
    ds_read_b64_tr_b16 v[24:25], v7 offset:47104
    ds_read_b64_tr_b16 v[26:27], v7 offset:47616
    v_mul_f32 v214, v214, v86
    v_mul_f32 v215, v215, v87
    v_cvt_pk_bf16_f32 v232, v208, v209
    v_cvt_pk_bf16_f32 v233, v210, v211
    v_mfma_f32_32x32x16_bf16 v[112:127], a[180:183], v[36:39], v[112:127]
    ds_read_b64_tr_b16 v[28:29], v8 offset:47104
    ds_read_b64_tr_b16 v[30:31], v8 offset:47616
    v_cvt_pk_bf16_f32 v234, v212, v213
    v_cvt_pk_bf16_f32 v235, v214, v215
    buffer_store_dwordx4 v[232:235], v9, s[28:31], s84 offen offset:0 sc1
    v_fmac_f32 v88, v48, v60
    s_waitcnt lgkmcnt(4)
    s_barrier
    v_mfma_f32_32x32x16_bf16 v[96:111], a[184:187], v[16:19], v[96:111]
    ds_read_b64_tr_b16 v[32:33], v7 offset:49152
    ds_read_b64_tr_b16 v[34:35], v7 offset:49664
    v_fmac_f32 v89, v49, v60
    v_fmac_f32 v90, v50, v60
    v_fmac_f32 v91, v51, v60
    v_fmac_f32 v92, v52, v60
    v_mfma_f32_32x32x16_bf16 v[112:127], a[184:187], v[20:23], v[112:127]
    ds_read_b64_tr_b16 v[36:37], v8 offset:49152
    ds_read_b64_tr_b16 v[38:39], v8 offset:49664
    v_fmac_f32 v93, v53, v60
    v_fmac_f32 v94, v54, v60
    v_fmac_f32 v95, v55, v60
    v_mul_f32 v216, v88, v61
    s_waitcnt lgkmcnt(4)
    v_mfma_f32_32x32x16_bf16 v[96:111], a[188:191], v[24:27], v[96:111]
    ds_read_b64_tr_b16 v[16:17], v7 offset:51200
    ds_read_b64_tr_b16 v[18:19], v7 offset:51712
    v_mul_f32 v217, v89, v61
    v_mul_f32 v218, v90, v61
    v_mul_f32 v219, v91, v61
    v_mul_f32 v220, v92, v61
    v_mfma_f32_32x32x16_bf16 v[112:127], a[188:191], v[28:31], v[112:127]
    ds_read_b64_tr_b16 v[20:21], v8 offset:51200
    ds_read_b64_tr_b16 v[22:23], v8 offset:51712
    v_mul_f32 v221, v93, v61
    v_mul_f32 v222, v94, v61
    v_mul_f32 v223, v95, v61
    v_exp_f32 v216, v216
    s_waitcnt lgkmcnt(4)
    v_mfma_f32_32x32x16_bf16 v[96:111], a[192:195], v[32:35], v[96:111]
    ds_read_b64_tr_b16 v[24:25], v7 offset:53248
    ds_read_b64_tr_b16 v[26:27], v7 offset:53760
    v_exp_f32 v217, v217
    v_exp_f32 v218, v218
    v_exp_f32 v219, v219
    v_exp_f32 v220, v220
    v_mfma_f32_32x32x16_bf16 v[112:127], a[192:195], v[36:39], v[112:127]
    ds_read_b64_tr_b16 v[28:29], v8 offset:53248
    ds_read_b64_tr_b16 v[30:31], v8 offset:53760
    v_exp_f32 v221, v221
    v_exp_f32 v222, v222
    v_exp_f32 v223, v223
    v_fma_f32 v216, v216, v62, v62
    s_waitcnt lgkmcnt(4)
    v_mfma_f32_32x32x16_bf16 v[96:111], a[196:199], v[16:19], v[96:111]
    ds_read_b64_tr_b16 v[32:33], v7 offset:55296
    ds_read_b64_tr_b16 v[34:35], v7 offset:55808
    v_fma_f32 v217, v217, v62, v62
    v_fma_f32 v218, v218, v62, v62
    v_fma_f32 v219, v219, v62, v62
    v_fma_f32 v220, v220, v62, v62
    v_mfma_f32_32x32x16_bf16 v[112:127], a[196:199], v[20:23], v[112:127]
    ds_read_b64_tr_b16 v[36:37], v8 offset:55296
    ds_read_b64_tr_b16 v[38:39], v8 offset:55808
    v_fma_f32 v221, v221, v62, v62
    v_fma_f32 v222, v222, v62, v62
    v_fma_f32 v223, v223, v62, v62
    v_rcp_f32 v216, v216
    s_waitcnt lgkmcnt(4)
    buffer_load_dwordx2 v[240:241], v11, s[28:31], s81 offen offset:512 sc1
    buffer_load_dwordx2 v[242:243], v11, s[28:31], s81 offen offset:768 sc1
    v_mfma_f32_32x32x16_bf16 v[96:111], a[200:203], v[24:27], v[96:111]
    ds_read_b64_tr_b16 v[16:17], v7 offset:57344
    ds_read_b64_tr_b16 v[18:19], v7 offset:57856
    v_rcp_f32 v217, v217
    v_rcp_f32 v218, v218
    v_rcp_f32 v219, v219
    v_rcp_f32 v220, v220
    v_mfma_f32_32x32x16_bf16 v[112:127], a[200:203], v[28:31], v[112:127]
    ds_read_b64_tr_b16 v[20:21], v8 offset:57344
    ds_read_b64_tr_b16 v[22:23], v8 offset:57856
    v_rcp_f32 v221, v221
    v_rcp_f32 v222, v222
    v_rcp_f32 v223, v223
    v_mul_f32 v216, v216, v88
    s_waitcnt lgkmcnt(4)
    v_mfma_f32_32x32x16_bf16 v[96:111], a[204:207], v[32:35], v[96:111]
    ds_read_b64_tr_b16 v[24:25], v7 offset:59392
    ds_read_b64_tr_b16 v[26:27], v7 offset:59904
    v_mul_f32 v217, v217, v89
    v_mul_f32 v218, v218, v90
    v_mul_f32 v219, v219, v91
    v_mul_f32 v220, v220, v92
    v_mfma_f32_32x32x16_bf16 v[112:127], a[204:207], v[36:39], v[112:127]
    ds_read_b64_tr_b16 v[28:29], v8 offset:59392
    ds_read_b64_tr_b16 v[30:31], v8 offset:59904
    v_mul_f32 v221, v221, v93
    v_mul_f32 v222, v222, v94
    v_mul_f32 v223, v223, v95
    v_cvt_pk_bf16_f32 v236, v216, v217
    s_waitcnt lgkmcnt(4)
    v_mfma_f32_32x32x16_bf16 v[96:111], a[208:211], v[16:19], v[96:111]
    ds_read_b64_tr_b16 v[32:33], v7 offset:61440
    ds_read_b64_tr_b16 v[34:35], v7 offset:61952
    v_cvt_pk_bf16_f32 v237, v218, v219
    v_cvt_pk_bf16_f32 v238, v220, v221
    v_cvt_pk_bf16_f32 v239, v222, v223
    buffer_store_dwordx4 v[236:239], v9, s[28:31], s84 offen offset:1024 sc1
    v_mfma_f32_32x32x16_bf16 v[112:127], a[208:211], v[20:23], v[112:127]
    ds_read_b64_tr_b16 v[36:37], v8 offset:61440
    ds_read_b64_tr_b16 v[38:39], v8 offset:61952
    s_waitcnt lgkmcnt(4)
    v_mfma_f32_32x32x16_bf16 v[96:111], a[212:215], v[24:27], v[96:111]
    ds_read_b64_tr_b16 v[16:17], v7 offset:63488
    ds_read_b64_tr_b16 v[18:19], v7 offset:64000
    v_mfma_f32_32x32x16_bf16 v[112:127], a[212:215], v[28:31], v[112:127]
    ds_read_b64_tr_b16 v[20:21], v8 offset:63488
    ds_read_b64_tr_b16 v[22:23], v8 offset:64000
    s_waitcnt lgkmcnt(4)
    v_mfma_f32_32x32x16_bf16 v[96:111], a[216:219], v[32:35], v[96:111]
    v_mfma_f32_32x32x16_bf16 v[112:127], a[216:219], v[36:39], v[112:127]
    s_waitcnt lgkmcnt(0)
    v_mfma_f32_32x32x16_bf16 v[96:111], a[220:223], v[16:19], v[96:111]
    v_mfma_f32_32x32x16_bf16 v[112:127], a[220:223], v[20:23], v[112:127]
    s_waitcnt vmcnt(0)
    v_mov_b32 v12, s7
    s_mov_b64 exec, 1
    s_cmp_eq_u32 s26, 0
    s_cbranch_scc1 FS27
    buffer_store_dword v12, off, s[28:31], s82
    s_branch FS28
FS27:
    buffer_store_dword v12, off, s[28:31], s82 sc1
FS28:
    s_mov_b64 exec, -1
    s_mov_b32 s96, 0
HSRE30:
    v_xor_b32 v12, s7, v241
    v_xor_b32 v13, s7, v243
    v_or_b32 v12, v12, v13
    v_cmp_ne_u32 vcc, 0, v12
    s_cbranch_vccz HSOK29
    s_add_u32 s96, s96, 1
    s_cmp_ge_u32 s96, 50000
    s_cbranch_scc1 HSOK29
    buffer_load_dwordx2 v[240:241], v11, s[28:31], s81 offen offset:512 sc1
    buffer_load_dwordx2 v[242:243], v11, s[28:31], s81 offen offset:768 sc1
    s_waitcnt vmcnt(0)
    s_branch HSRE30
HSOK29:
    v_and_b32 v58, 0xffff0000, v240
    v_lshlrev_b32 v56, 16, v240
    v_rcp_f32 v57, v58
    v_xor_b32 v56, 0x80000000, v56
    v_mul_f32 v57, 0xbfb8aa3b, v57
    v_and_b32 v62, 0xffff0000, v242
    v_lshlrev_b32 v60, 16, v242
    v_rcp_f32 v61, v62
    v_xor_b32 v60, 0x80000000, v60
    v_mul_f32 v61, 0xbfb8aa3b, v61
    v_add_u32 v12, s87, v3
    v_add_u32 v13, s87, v4
    s_barrier
    ds_read_b64_tr_b16 a[112:113], v12 offset:0
    ds_read_b64_tr_b16 a[114:115], v12 offset:1024
    ds_read_b64_tr_b16 a[116:117], v13 offset:0
    ds_read_b64_tr_b16 a[118:119], v13 offset:1024
    ds_read_b64_tr_b16 a[120:121], v12 offset:2048
    ds_read_b64_tr_b16 a[122:123], v12 offset:3072
    ds_read_b64_tr_b16 a[124:125], v13 offset:2048
    ds_read_b64_tr_b16 a[126:127], v13 offset:3072
    ds_read_b64_tr_b16 a[128:129], v12 offset:4096
    ds_read_b64_tr_b16 a[130:131], v12 offset:5120
    ds_read_b64_tr_b16 a[132:133], v13 offset:4096
    ds_read_b64_tr_b16 a[134:135], v13 offset:5120
    ds_read_b64_tr_b16 a[136:137], v12 offset:6144
    ds_read_b64_tr_b16 a[138:139], v12 offset:7168
    ds_read_b64_tr_b16 a[140:141], v13 offset:6144
    ds_read_b64_tr_b16 a[142:143], v13 offset:7168
    ds_read_b64_tr_b16 a[144:145], v12 offset:8192
    ds_read_b64_tr_b16 a[146:147], v12 offset:9216
    ds_read_b64_tr_b16 a[148:149], v13 offset:8192
    ds_read_b64_tr_b16 a[150:151], v13 offset:9216
    ds_read_b64_tr_b16 a[152:153], v12 offset:10240
    ds_read_b64_tr_b16 a[154:155], v12 offset:11264
    ds_read_b64_tr_b16 a[156:157], v13 offset:10240
    ds_read_b64_tr_b16 a[158:159], v13 offset:11264
    s_add_u32 s87, s87, 65536
    v_lshlrev_b32 v247, 4, v1
    v_lshrrev_b32 v244, 2, v1
    v_and_b32 v245, 3, v1
    v_bfe_u32 v246, v244, 1, 1
    s_and_b32 s68, s17, 1
    v_xor_b32 v246, s68, v246
    v_lshlrev_b32 v246, 6, v246
    v_lshl_add_u32 v246, v245, 4, v246
    v_lshl_add_u32 v246, v244, 7, v246
    s_lshr_b32 s69, s17, 1
    s_lshl_b32 s70, s69, 16
    s_lshl_b32 s71, s16, 12
    s_add_u32 s70, s70, s71
    s_lshl_b32 s71, s9, 11
    s_add_u32 s70, s70, s71
    s_add_u32 s70, s70, 5242880
    s_add_u32 s71, s70, 64512
    s_lshl_b32 s21, s4, 11
    s_add_u32 s21, s21, 155648
    s_mov_b32 m0, s21
    s_nop 0
    buffer_load_dwordx4 v246, s[28:31], s70 offen sc1 lds
    buffer_load_dwordx4 v246, s[28:31], s71 offen offset:1024 sc1 lds
    s_mul_i32 s72, s4, 28672
    s_add_u32 s72, s72, 12582912
    s_mul_i32 s73, s17, 114688
    s_add_u32 s73, s73, s72
    s_add_u32 s75, s73, 28672
    s_lshl_b32 s88, s23, 12
    s_add_u32 s73, s73, s88
    v_min_u32 v244, 13, v1
    s_mul_i32 s74, s4, 56
    v_lshlrev_b32 v244, 2, v244
    s_and_b32 s69, s14, 1
    s_lshl_b32 s69, s69, 9
    s_add_u32 s69, s69, s74
    s_add_u32 s69, s69, s3
    s_add_u32 s69, s69, 1024
    v_add_u32 v248, s69, v244
    v_add_u32 v249, 256, v248
    v_pk_fma_f32 v[96:97], v[40:41], v[56:57], v[96:97] op_sel_hi:[1,0,1]
    v_pk_fma_f32 v[98:99], v[42:43], v[56:57], v[98:99] op_sel_hi:[1,0,1]
    v_pk_fma_f32 v[100:101], v[44:45], v[56:57], v[100:101] op_sel_hi:[1,0,1]
    v_pk_fma_f32 v[102:103], v[46:47], v[56:57], v[102:103] op_sel_hi:[1,0,1]
    s_mov_b32 m0, s87
    s_nop 0
    buffer_load_dwordx4 v2, s[60:63], s18 offen lds
    s_add_u32 s18, s18, 8192
    s_add_u32 m0, m0, 1024
    s_cmp_eq_u32 s18, s22
    s_cselect_b32 s97, 458752, 0
    s_sub_u32 s18, s18, s97
    v_pk_mul_f32 v[192:193], v[96:97], v[56:57] op_sel:[0,1] op_sel_hi:[1,1]
    v_pk_mul_f32 v[194:195], v[98:99], v[56:57] op_sel:[0,1] op_sel_hi:[1,1]
    v_pk_mul_f32 v[196:197], v[100:101], v[56:57] op_sel:[0,1] op_sel_hi:[1,1]
    v_pk_mul_f32 v[198:199], v[102:103], v[56:57] op_sel:[0,1] op_sel_hi:[1,1]
    v_exp_f32 v192, v192
    v_exp_f32 v193, v193
    v_exp_f32 v194, v194
    v_exp_f32 v195, v195
    buffer_load_dwordx4 v2, s[60:63], s18 offen lds
    s_add_u32 s18, s18, 8192
    s_add_u32 m0, m0, 1024
    s_cmp_eq_u32 s18, s22
    s_cselect_b32 s97, 458752, 0
    s_sub_u32 s18, s18, s97
    v_exp_f32 v196, v196
    v_exp_f32 v197, v197
    v_exp_f32 v198, v198
    v_exp_f32 v199, v199
    v_pk_fma_f32 v[192:193], v[192:193], v[58:59], v[58:59] op_sel_hi:[1,0,0]
    v_pk_fma_f32 v[194:195], v[194:195], v[58:59], v[58:59] op_sel_hi:[1,0,0]
    v_pk_fma_f32 v[196:197], v[196:197], v[58:59], v[58:59] op_sel_hi:[1,0,0]
    v_pk_fma_f32 v[198:199], v[198:199], v[58:59], v[58:59] op_sel_hi:[1,0,0]
    buffer_load_dwordx4 v2, s[60:63], s18 offen lds
    s_add_u32 s18, s18, 8192
    s_add_u32 m0, m0, 1024
    s_cmp_eq_u32 s18, s22
    s_cselect_b32 s97, 458752, 0
    s_sub_u32 s18, s18, s97
    v_rcp_f32 v192, v192
    v_rcp_f32 v193, v193
    v_rcp_f32 v194, v194
    v_rcp_f32 v195, v195
    v_rcp_f32 v196, v196
    v_rcp_f32 v197, v197
    v_rcp_f32 v198, v198
    v_rcp_f32 v199, v199
    buffer_load_dwordx4 v2, s[60:63], s18 offen lds
    s_add_u32 s18, s18, 8192
    s_add_u32 m0, m0, 1024
    s_cmp_eq_u32 s18, s22
    s_cselect_b32 s97, 458752, 0
    s_sub_u32 s18, s18, s97
    v_pk_mul_f32 v[192:193], v[192:193], v[96:97]
    v_pk_mul_f32 v[194:195], v[194:195], v[98:99]
    v_pk_mul_f32 v[196:197], v[196:197], v[100:101]
    v_pk_mul_f32 v[198:199], v[198:199], v[102:103]
    v_cvt_pk_bf16_f32 v224, v192, v193
    v_cvt_pk_bf16_f32 v225, v194, v195
    v_cvt_pk_bf16_f32 v226, v196, v197
    v_cvt_pk_bf16_f32 v227, v198, v199
    buffer_load_dwordx4 v2, s[60:63], s18 offen lds
    s_add_u32 s18, s18, 8192
    s_add_u32 m0, m0, 1024
    s_cmp_eq_u32 s18, s22
    s_cselect_b32 s97, 458752, 0
    s_sub_u32 s18, s18, s97
    buffer_store_dwordx4 v[224:227], v9, s[28:31], s85 offen offset:0 sc1
    v_pk_fma_f32 v[104:105], v[48:49], v[56:57], v[104:105] op_sel_hi:[1,0,1]
    v_pk_fma_f32 v[106:107], v[50:51], v[56:57], v[106:107] op_sel_hi:[1,0,1]
    v_pk_fma_f32 v[108:109], v[52:53], v[56:57], v[108:109] op_sel_hi:[1,0,1]
    v_pk_fma_f32 v[110:111], v[54:55], v[56:57], v[110:111] op_sel_hi:[1,0,1]
    v_pk_mul_f32 v[200:201], v[104:105], v[56:57] op_sel:[0,1] op_sel_hi:[1,1]
    v_pk_mul_f32 v[202:203], v[106:107], v[56:57] op_sel:[0,1] op_sel_hi:[1,1]
    v_pk_mul_f32 v[204:205], v[108:109], v[56:57] op_sel:[0,1] op_sel_hi:[1,1]
    buffer_load_dwordx4 v2, s[60:63], s18 offen lds
    s_add_u32 s18, s18, 8192
    s_add_u32 m0, m0, 1024
    s_cmp_eq_u32 s18, s22
    s_cselect_b32 s97, 458752, 0
    s_sub_u32 s18, s18, s97
    v_pk_mul_f32 v[206:207], v[110:111], v[56:57] op_sel:[0,1] op_sel_hi:[1,1]
    v_exp_f32 v200, v200
    v_exp_f32 v201, v201
    v_exp_f32 v202, v202
    v_exp_f32 v203, v203
    v_exp_f32 v204, v204
    v_exp_f32 v205, v205
    v_exp_f32 v206, v206
    buffer_load_dwordx4 v2, s[60:63], s18 offen lds
    s_add_u32 s18, s18, 8192
    s_add_u32 m0, m0, 1024
    s_cmp_eq_u32 s18, s22
    s_cselect_b32 s97, 458752, 0
    s_sub_u32 s18, s18, s97
    v_exp_f32 v207, v207
    v_pk_fma_f32 v[200:201], v[200:201], v[58:59], v[58:59] op_sel_hi:[1,0,0]
    v_pk_fma_f32 v[202:203], v[202:203], v[58:59], v[58:59] op_sel_hi:[1,0,0]
    v_pk_fma_f32 v[204:205], v[204:205], v[58:59], v[58:59] op_sel_hi:[1,0,0]
    v_pk_fma_f32 v[206:207], v[206:207], v[58:59], v[58:59] op_sel_hi:[1,0,0]
    v_rcp_f32 v200, v200
    v_rcp_f32 v201, v201
    v_rcp_f32 v202, v202
    buffer_load_dwordx4 v2, s[60:63], s18 offen lds
    s_add_u32 s18, s18, 8192
    s_add_u32 m0, m0, 1024
    s_cmp_eq_u32 s18, s22
    s_cselect_b32 s97, 458752, 0
    s_sub_u32 s18, s18, s97
    v_rcp_f32 v203, v203
    v_rcp_f32 v204, v204
    v_rcp_f32 v205, v205
    v_rcp_f32 v206, v206
    v_rcp_f32 v207, v207
    v_pk_mul_f32 v[200:201], v[200:201], v[104:105]
    v_pk_mul_f32 v[202:203], v[202:203], v[106:107]
    v_pk_mul_f32 v[204:205], v[204:205], v[108:109]
    buffer_load_dwordx4 v2, s[60:63], s18 offen lds
    s_add_u32 s18, s18, 8192
    s_add_u32 m0, m0, 1024
    s_cmp_eq_u32 s18, s22
    s_cselect_b32 s97, 458752, 0
    s_sub_u32 s18, s18, s97
    v_pk_mul_f32 v[206:207], v[206:207], v[110:111]
    v_cvt_pk_bf16_f32 v228, v200, v201
    v_cvt_pk_bf16_f32 v229, v202, v203
    v_cvt_pk_bf16_f32 v230, v204, v205
    v_cvt_pk_bf16_f32 v231, v206, v207
    buffer_store_dwordx4 v[228:231], v9, s[28:31], s85 offen offset:1024 sc1
    v_pk_fma_f32 v[112:113], v[40:41], v[60:61], v[112:113] op_sel_hi:[1,0,1]
    v_pk_fma_f32 v[114:115], v[42:43], v[60:61], v[114:115] op_sel_hi:[1,0,1]
    buffer_load_dwordx4 v2, s[60:63], s18 offen lds
    s_add_u32 s18, s18, 8192
    s_add_u32 m0, m0, 1024
    s_cmp_eq_u32 s18, s22
    s_cselect_b32 s97, 458752, 0
    s_sub_u32 s18, s18, s97
    v_pk_fma_f32 v[116:117], v[44:45], v[60:61], v[116:117] op_sel_hi:[1,0,1]
    v_pk_fma_f32 v[118:119], v[46:47], v[60:61], v[118:119] op_sel_hi:[1,0,1]
    v_pk_mul_f32 v[208:209], v[112:113], v[60:61] op_sel:[0,1] op_sel_hi:[1,1]
    v_pk_mul_f32 v[210:211], v[114:115], v[60:61] op_sel:[0,1] op_sel_hi:[1,1]
    v_pk_mul_f32 v[212:213], v[116:117], v[60:61] op_sel:[0,1] op_sel_hi:[1,1]
    v_pk_mul_f32 v[214:215], v[118:119], v[60:61] op_sel:[0,1] op_sel_hi:[1,1]
    v_exp_f32 v208, v208
    v_exp_f32 v209, v209
    buffer_load_dwordx4 v2, s[60:63], s18 offen lds
    s_add_u32 s18, s18, 8192
    s_add_u32 m0, m0, 1024
    s_cmp_eq_u32 s18, s22
    s_cselect_b32 s97, 458752, 0
    s_sub_u32 s18, s18, s97
    v_exp_f32 v210, v210
    v_exp_f32 v211, v211
    v_exp_f32 v212, v212
    v_exp_f32 v213, v213
    v_exp_f32 v214, v214
    v_exp_f32 v215, v215
    v_pk_fma_f32 v[208:209], v[208:209], v[62:63], v[62:63] op_sel_hi:[1,0,0]
    v_pk_fma_f32 v[210:211], v[210:211], v[62:63], v[62:63] op_sel_hi:[1,0,0]
    buffer_load_dwordx4 v2, s[60:63], s18 offen lds
    s_add_u32 s18, s18, 8192
    s_add_u32 m0, m0, 1024
    s_cmp_eq_u32 s18, s22
    s_cselect_b32 s97, 458752, 0
    s_sub_u32 s18, s18, s97
    v_pk_fma_f32 v[212:213], v[212:213], v[62:63], v[62:63] op_sel_hi:[1,0,0]
    v_pk_fma_f32 v[214:215], v[214:215], v[62:63], v[62:63] op_sel_hi:[1,0,0]
    v_rcp_f32 v208, v208
    v_rcp_f32 v209, v209
    v_rcp_f32 v210, v210
    v_rcp_f32 v211, v211
    v_rcp_f32 v212, v212
    v_rcp_f32 v213, v213
    buffer_load_dwordx4 v2, s[60:63], s18 offen lds
    s_add_u32 s18, s18, 8192
    s_add_u32 m0, m0, 1024
    s_cmp_eq_u32 s18, s22
    s_cselect_b32 s97, 458752, 0
    s_sub_u32 s18, s18, s97
    v_rcp_f32 v214, v214
    v_rcp_f32 v215, v215
    v_pk_mul_f32 v[208:209], v[208:209], v[112:113]
    v_pk_mul_f32 v[210:211], v[210:211], v[114:115]
    v_pk_mul_f32 v[212:213], v[212:213], v[116:117]
    v_pk_mul_f32 v[214:215], v[214:215], v[118:119]
    v_cvt_pk_bf16_f32 v232, v208, v209
    v_cvt_pk_bf16_f32 v233, v210, v211
    buffer_load_dwordx4 v2, s[60:63], s18 offen lds
    s_add_u32 s18, s18, 8192
    s_add_u32 m0, m0, 1024
    s_cmp_eq_u32 s18, s22
    s_cselect_b32 s97, 458752, 0
    s_sub_u32 s18, s18, s97
    v_cvt_pk_bf16_f32 v234, v212, v213
    buffer_load_dword v250, v248, s[28:31], 0 offen sc1
    v_cvt_pk_bf16_f32 v235, v214, v215
    buffer_store_dwordx4 v[232:235], v9, s[28:31], s86 offen offset:0 sc1
    v_pk_fma_f32 v[120:121], v[48:49], v[60:61], v[120:121] op_sel_hi:[1,0,1]
    v_pk_fma_f32 v[122:123], v[50:51], v[60:61], v[122:123] op_sel_hi:[1,0,1]
    v_pk_fma_f32 v[124:125], v[52:53], v[60:61], v[124:125] op_sel_hi:[1,0,1]
    v_pk_fma_f32 v[126:127], v[54:55], v[60:61], v[126:127] op_sel_hi:[1,0,1]
    v_pk_mul_f32 v[216:217], v[120:121], v[60:61] op_sel:[0,1] op_sel_hi:[1,1]
    buffer_load_dwordx4 v2, s[60:63], s18 offen lds
    s_add_u32 s18, s18, 8192
    s_add_u32 m0, m0, 1024
    s_cmp_eq_u32 s18, s22
    s_cselect_b32 s97, 458752, 0
    s_sub_u32 s18, s18, s97
    v_pk_mul_f32 v[218:219], v[122:123], v[60:61] op_sel:[0,1] op_sel_hi:[1,1]
    v_pk_mul_f32 v[220:221], v[124:125], v[60:61] op_sel:[0,1] op_sel_hi:[1,1]
    v_pk_mul_f32 v[222:223], v[126:127], v[60:61] op_sel:[0,1] op_sel_hi:[1,1]
    v_exp_f32 v216, v216
    v_exp_f32 v217, v217
    v_exp_f32 v218, v218
    v_exp_f32 v219, v219
    v_exp_f32 v220, v220
    buffer_load_dwordx4 v2, s[60:63], s18 offen lds
    s_add_u32 s18, s18, 8192
    s_add_u32 m0, m0, 1024
    s_cmp_eq_u32 s18, s22
    s_cselect_b32 s97, 458752, 0
    s_sub_u32 s18, s18, s97
    v_exp_f32 v221, v221
    v_exp_f32 v222, v222
    v_exp_f32 v223, v223
    v_pk_fma_f32 v[216:217], v[216:217], v[62:63], v[62:63] op_sel_hi:[1,0,0]
    v_pk_fma_f32 v[218:219], v[218:219], v[62:63], v[62:63] op_sel_hi:[1,0,0]
    v_pk_fma_f32 v[220:221], v[220:221], v[62:63], v[62:63] op_sel_hi:[1,0,0]
    v_pk_fma_f32 v[222:223], v[222:223], v[62:63], v[62:63] op_sel_hi:[1,0,0]
    v_rcp_f32 v216, v216
    v_rcp_f32 v217, v217
    v_rcp_f32 v218, v218
    v_rcp_f32 v219, v219
    v_rcp_f32 v220, v220
    v_rcp_f32 v221, v221
    v_rcp_f32 v222, v222
    v_rcp_f32 v223, v223
    v_pk_mul_f32 v[216:217], v[216:217], v[120:121]
    v_pk_mul_f32 v[218:219], v[218:219], v[122:123]
    v_pk_mul_f32 v[220:221], v[220:221], v[124:125]
    v_pk_mul_f32 v[222:223], v[222:223], v[126:127]
    v_cvt_pk_bf16_f32 v236, v216, v217
    v_cvt_pk_bf16_f32 v237, v218, v219
    v_cvt_pk_bf16_f32 v238, v220, v221
    v_cvt_pk_bf16_f32 v239, v222, v223
    buffer_store_dwordx4 v[236:239], v9, s[28:31], s86 offen offset:1024 sc1
    s_add_u32 s82, s82, 256
    v_add_u32 v15, s87, v3
    v_add_u32 v16, s87, v4
    s_mov_b32 s95, 1
    s_waitcnt vmcnt(4)
    v_cmp_ne_u32 vcc, s7, v250
    s_cbranch_vccz P3_START
    s_mov_b32 s96, 0
POLL32:
    buffer_load_dword v250, v248, s[28:31], 0 offen sc1
    s_waitcnt vmcnt(0)
    v_cmp_ne_u32 vcc, s7, v250
    s_cbranch_vccz PDONE33
    s_add_u32 s96, s96, 1
    s_cmp_lt_u32 s96, 50000
    s_cbranch_scc1 POLL32
PDONE33:
    s_branch P3_START
P2_STATS:
    s_sub_u32 s76, s12, 14
    v_and_b32 v5, 7, v0
    v_lshrrev_b32 v6, 3, v0
    v_bfe_u32 v7, v6, 1, 1
    v_lshlrev_b32 v7, 2, v7
    v_xor_b32 v7, v7, v5
    v_lshlrev_b32 v7, 4, v7
    v_lshl_add_u32 v7, v6, 7, v7
    s_lshl_b32 s79, s11, 1
    s_add_u32 s79, s79, s76
    s_lshl_b32 s79, s79, 16
    s_add_u32 s79, s79, 5242880
    buffer_load_dwordx4 v[64:67], v7, s[28:31], s79 offen sc1
    s_add_u32 s79, s79, 4096
    buffer_load_dwordx4 v[68:71], v7, s[28:31], s79 offen sc1
    s_add_u32 s79, s79, 4096
    buffer_load_dwordx4 v[72:75], v7, s[28:31], s79 offen sc1
    s_add_u32 s79, s79, 4096
    buffer_load_dwordx4 v[76:79], v7, s[28:31], s79 offen sc1
    s_add_u32 s79, s79, 4096
    buffer_load_dwordx4 v[80:83], v7, s[28:31], s79 offen sc1
    s_add_u32 s79, s79, 4096
    buffer_load_dwordx4 v[84:87], v7, s[28:31], s79 offen sc1
    s_add_u32 s79, s79, 4096
    buffer_load_dwordx4 v[88:91], v7, s[28:31], s79 offen sc1
    s_add_u32 s79, s79, 4096
    buffer_load_dwordx4 v[92:95], v7, s[28:31], s79 offen sc1
    s_add_u32 s79, s79, 4096
    buffer_load_dwordx4 v[96:99], v7, s[28:31], s79 offen sc1
    s_add_u32 s79, s79, 4096
    buffer_load_dwordx4 v[100:103], v7, s[28:31], s79 offen sc1
    s_add_u32 s79, s79, 4096
    buffer_load_dwordx4 v[104:107], v7, s[28:31], s79 offen sc1
    s_add_u32 s79, s79, 4096
    buffer_load_dwordx4 v[108:111], v7, s[28:31], s79 offen sc1
    s_add_u32 s79, s79, 4096
    buffer_load_dwordx4 v[112:115], v7, s[28:31], s79 offen sc1
    s_add_u32 s79, s79, 4096
    buffer_load_dwordx4 v[116:119], v7, s[28:31], s79 offen sc1
    s_add_u32 s79, s79, 4096
    buffer_load_dwordx4 v[120:123], v7, s[28:31], s79 offen sc1
    s_add_u32 s79, s79, 4096
    buffer_load_dwordx4 v[124:127], v7, s[28:31], s79 offen sc1
    s_add_u32 s79, s79, 4096
    v_mov_b32 v32, 0
    v_mov_b32 v33, 0
    v_mov_b32 v34, 0
    v_mov_b32 v35, 0
    v_mov_b32 v36, 0
    v_mov_b32 v37, 0
    v_mov_b32 v38, 0
    v_mov_b32 v39, 0
    v_mov_b32 v40, 0
    v_mov_b32 v41, 0
    v_mov_b32 v42, 0
    v_mov_b32 v43, 0
    v_mov_b32 v44, 0
    v_mov_b32 v45, 0
    v_mov_b32 v46, 0
    v_mov_b32 v47, 0
    s_waitcnt vmcnt(15)
    v_lshlrev_b32 v20, 16, v64
    v_and_b32 v21, 0xffff0000, v64
    v_pk_add_f32 v[32:33], v[32:33], v[20:21]
    v_pk_fma_f32 v[40:41], v[20:21], v[20:21], v[40:41]
    v_lshlrev_b32 v22, 16, v65
    v_and_b32 v23, 0xffff0000, v65
    v_pk_add_f32 v[34:35], v[34:35], v[22:23]
    v_pk_fma_f32 v[42:43], v[22:23], v[22:23], v[42:43]
    v_lshlrev_b32 v20, 16, v66
    v_and_b32 v21, 0xffff0000, v66
    v_pk_add_f32 v[36:37], v[36:37], v[20:21]
    v_pk_fma_f32 v[44:45], v[20:21], v[20:21], v[44:45]
    v_lshlrev_b32 v22, 16, v67
    v_and_b32 v23, 0xffff0000, v67
    v_pk_add_f32 v[38:39], v[38:39], v[22:23]
    v_pk_fma_f32 v[46:47], v[22:23], v[22:23], v[46:47]
    s_waitcnt vmcnt(14)
    v_lshlrev_b32 v20, 16, v68
    v_and_b32 v21, 0xffff0000, v68
    v_pk_add_f32 v[32:33], v[32:33], v[20:21]
    v_pk_fma_f32 v[40:41], v[20:21], v[20:21], v[40:41]
    v_lshlrev_b32 v22, 16, v69
    v_and_b32 v23, 0xffff0000, v69
    v_pk_add_f32 v[34:35], v[34:35], v[22:23]
    v_pk_fma_f32 v[42:43], v[22:23], v[22:23], v[42:43]
    v_lshlrev_b32 v20, 16, v70
    v_and_b32 v21, 0xffff0000, v70
    v_pk_add_f32 v[36:37], v[36:37], v[20:21]
    v_pk_fma_f32 v[44:45], v[20:21], v[20:21], v[44:45]
    v_lshlrev_b32 v22, 16, v71
    v_and_b32 v23, 0xffff0000, v71
    v_pk_add_f32 v[38:39], v[38:39], v[22:23]
    v_pk_fma_f32 v[46:47], v[22:23], v[22:23], v[46:47]
    s_waitcnt vmcnt(13)
    v_lshlrev_b32 v20, 16, v72
    v_and_b32 v21, 0xffff0000, v72
    v_pk_add_f32 v[32:33], v[32:33], v[20:21]
    v_pk_fma_f32 v[40:41], v[20:21], v[20:21], v[40:41]
    v_lshlrev_b32 v22, 16, v73
    v_and_b32 v23, 0xffff0000, v73
    v_pk_add_f32 v[34:35], v[34:35], v[22:23]
    v_pk_fma_f32 v[42:43], v[22:23], v[22:23], v[42:43]
    v_lshlrev_b32 v20, 16, v74
    v_and_b32 v21, 0xffff0000, v74
    v_pk_add_f32 v[36:37], v[36:37], v[20:21]
    v_pk_fma_f32 v[44:45], v[20:21], v[20:21], v[44:45]
    v_lshlrev_b32 v22, 16, v75
    v_and_b32 v23, 0xffff0000, v75
    v_pk_add_f32 v[38:39], v[38:39], v[22:23]
    v_pk_fma_f32 v[46:47], v[22:23], v[22:23], v[46:47]
    s_waitcnt vmcnt(12)
    v_lshlrev_b32 v20, 16, v76
    v_and_b32 v21, 0xffff0000, v76
    v_pk_add_f32 v[32:33], v[32:33], v[20:21]
    v_pk_fma_f32 v[40:41], v[20:21], v[20:21], v[40:41]
    v_lshlrev_b32 v22, 16, v77
    v_and_b32 v23, 0xffff0000, v77
    v_pk_add_f32 v[34:35], v[34:35], v[22:23]
    v_pk_fma_f32 v[42:43], v[22:23], v[22:23], v[42:43]
    v_lshlrev_b32 v20, 16, v78
    v_and_b32 v21, 0xffff0000, v78
    v_pk_add_f32 v[36:37], v[36:37], v[20:21]
    v_pk_fma_f32 v[44:45], v[20:21], v[20:21], v[44:45]
    v_lshlrev_b32 v22, 16, v79
    v_and_b32 v23, 0xffff0000, v79
    v_pk_add_f32 v[38:39], v[38:39], v[22:23]
    v_pk_fma_f32 v[46:47], v[22:23], v[22:23], v[46:47]
    s_waitcnt vmcnt(11)
    v_lshlrev_b32 v20, 16, v80
    v_and_b32 v21, 0xffff0000, v80
    v_pk_add_f32 v[32:33], v[32:33], v[20:21]
    v_pk_fma_f32 v[40:41], v[20:21], v[20:21], v[40:41]
    v_lshlrev_b32 v22, 16, v81
    v_and_b32 v23, 0xffff0000, v81
    v_pk_add_f32 v[34:35], v[34:35], v[22:23]
    v_pk_fma_f32 v[42:43], v[22:23], v[22:23], v[42:43]
    v_lshlrev_b32 v20, 16, v82
    v_and_b32 v21, 0xffff0000, v82
    v_pk_add_f32 v[36:37], v[36:37], v[20:21]
    v_pk_fma_f32 v[44:45], v[20:21], v[20:21], v[44:45]
    v_lshlrev_b32 v22, 16, v83
    v_and_b32 v23, 0xffff0000, v83
    v_pk_add_f32 v[38:39], v[38:39], v[22:23]
    v_pk_fma_f32 v[46:47], v[22:23], v[22:23], v[46:47]
    s_waitcnt vmcnt(10)
    v_lshlrev_b32 v20, 16, v84
    v_and_b32 v21, 0xffff0000, v84
    v_pk_add_f32 v[32:33], v[32:33], v[20:21]
    v_pk_fma_f32 v[40:41], v[20:21], v[20:21], v[40:41]
    v_lshlrev_b32 v22, 16, v85
    v_and_b32 v23, 0xffff0000, v85
    v_pk_add_f32 v[34:35], v[34:35], v[22:23]
    v_pk_fma_f32 v[42:43], v[22:23], v[22:23], v[42:43]
    v_lshlrev_b32 v20, 16, v86
    v_and_b32 v21, 0xffff0000, v86
    v_pk_add_f32 v[36:37], v[36:37], v[20:21]
    v_pk_fma_f32 v[44:45], v[20:21], v[20:21], v[44:45]
    v_lshlrev_b32 v22, 16, v87
    v_and_b32 v23, 0xffff0000, v87
    v_pk_add_f32 v[38:39], v[38:39], v[22:23]
    v_pk_fma_f32 v[46:47], v[22:23], v[22:23], v[46:47]
    s_waitcnt vmcnt(9)
    v_lshlrev_b32 v20, 16, v88
    v_and_b32 v21, 0xffff0000, v88
    v_pk_add_f32 v[32:33], v[32:33], v[20:21]
    v_pk_fma_f32 v[40:41], v[20:21], v[20:21], v[40:41]
    v_lshlrev_b32 v22, 16, v89
    v_and_b32 v23, 0xffff0000, v89
    v_pk_add_f32 v[34:35], v[34:35], v[22:23]
    v_pk_fma_f32 v[42:43], v[22:23], v[22:23], v[42:43]
    v_lshlrev_b32 v20, 16, v90
    v_and_b32 v21, 0xffff0000, v90
    v_pk_add_f32 v[36:37], v[36:37], v[20:21]
    v_pk_fma_f32 v[44:45], v[20:21], v[20:21], v[44:45]
    v_lshlrev_b32 v22, 16, v91
    v_and_b32 v23, 0xffff0000, v91
    v_pk_add_f32 v[38:39], v[38:39], v[22:23]
    v_pk_fma_f32 v[46:47], v[22:23], v[22:23], v[46:47]
    s_waitcnt vmcnt(8)
    v_lshlrev_b32 v20, 16, v92
    v_and_b32 v21, 0xffff0000, v92
    v_pk_add_f32 v[32:33], v[32:33], v[20:21]
    v_pk_fma_f32 v[40:41], v[20:21], v[20:21], v[40:41]
    v_lshlrev_b32 v22, 16, v93
    v_and_b32 v23, 0xffff0000, v93
    v_pk_add_f32 v[34:35], v[34:35], v[22:23]
    v_pk_fma_f32 v[42:43], v[22:23], v[22:23], v[42:43]
    v_lshlrev_b32 v20, 16, v94
    v_and_b32 v21, 0xffff0000, v94
    v_pk_add_f32 v[36:37], v[36:37], v[20:21]
    v_pk_fma_f32 v[44:45], v[20:21], v[20:21], v[44:45]
    v_lshlrev_b32 v22, 16, v95
    v_and_b32 v23, 0xffff0000, v95
    v_pk_add_f32 v[38:39], v[38:39], v[22:23]
    v_pk_fma_f32 v[46:47], v[22:23], v[22:23], v[46:47]
    s_waitcnt vmcnt(7)
    v_lshlrev_b32 v20, 16, v96
    v_and_b32 v21, 0xffff0000, v96
    v_pk_add_f32 v[32:33], v[32:33], v[20:21]
    v_pk_fma_f32 v[40:41], v[20:21], v[20:21], v[40:41]
    v_lshlrev_b32 v22, 16, v97
    v_and_b32 v23, 0xffff0000, v97
    v_pk_add_f32 v[34:35], v[34:35], v[22:23]
    v_pk_fma_f32 v[42:43], v[22:23], v[22:23], v[42:43]
    v_lshlrev_b32 v20, 16, v98
    v_and_b32 v21, 0xffff0000, v98
    v_pk_add_f32 v[36:37], v[36:37], v[20:21]
    v_pk_fma_f32 v[44:45], v[20:21], v[20:21], v[44:45]
    v_lshlrev_b32 v22, 16, v99
    v_and_b32 v23, 0xffff0000, v99
    v_pk_add_f32 v[38:39], v[38:39], v[22:23]
    v_pk_fma_f32 v[46:47], v[22:23], v[22:23], v[46:47]
    s_waitcnt vmcnt(6)
    v_lshlrev_b32 v20, 16, v100
    v_and_b32 v21, 0xffff0000, v100
    v_pk_add_f32 v[32:33], v[32:33], v[20:21]
    v_pk_fma_f32 v[40:41], v[20:21], v[20:21], v[40:41]
    v_lshlrev_b32 v22, 16, v101
    v_and_b32 v23, 0xffff0000, v101
    v_pk_add_f32 v[34:35], v[34:35], v[22:23]
    v_pk_fma_f32 v[42:43], v[22:23], v[22:23], v[42:43]
    v_lshlrev_b32 v20, 16, v102
    v_and_b32 v21, 0xffff0000, v102
    v_pk_add_f32 v[36:37], v[36:37], v[20:21]
    v_pk_fma_f32 v[44:45], v[20:21], v[20:21], v[44:45]
    v_lshlrev_b32 v22, 16, v103
    v_and_b32 v23, 0xffff0000, v103
    v_pk_add_f32 v[38:39], v[38:39], v[22:23]
    v_pk_fma_f32 v[46:47], v[22:23], v[22:23], v[46:47]
    s_waitcnt vmcnt(5)
    v_lshlrev_b32 v20, 16, v104
    v_and_b32 v21, 0xffff0000, v104
    v_pk_add_f32 v[32:33], v[32:33], v[20:21]
    v_pk_fma_f32 v[40:41], v[20:21], v[20:21], v[40:41]
    v_lshlrev_b32 v22, 16, v105
    v_and_b32 v23, 0xffff0000, v105
    v_pk_add_f32 v[34:35], v[34:35], v[22:23]
    v_pk_fma_f32 v[42:43], v[22:23], v[22:23], v[42:43]
    v_lshlrev_b32 v20, 16, v106
    v_and_b32 v21, 0xffff0000, v106
    v_pk_add_f32 v[36:37], v[36:37], v[20:21]
    v_pk_fma_f32 v[44:45], v[20:21], v[20:21], v[44:45]
    v_lshlrev_b32 v22, 16, v107
    v_and_b32 v23, 0xffff0000, v107
    v_pk_add_f32 v[38:39], v[38:39], v[22:23]
    v_pk_fma_f32 v[46:47], v[22:23], v[22:23], v[46:47]
    s_waitcnt vmcnt(4)
    v_lshlrev_b32 v20, 16, v108
    v_and_b32 v21, 0xffff0000, v108
    v_pk_add_f32 v[32:33], v[32:33], v[20:21]
    v_pk_fma_f32 v[40:41], v[20:21], v[20:21], v[40:41]
    v_lshlrev_b32 v22, 16, v109
    v_and_b32 v23, 0xffff0000, v109
    v_pk_add_f32 v[34:35], v[34:35], v[22:23]
    v_pk_fma_f32 v[42:43], v[22:23], v[22:23], v[42:43]
    v_lshlrev_b32 v20, 16, v110
    v_and_b32 v21, 0xffff0000, v110
    v_pk_add_f32 v[36:37], v[36:37], v[20:21]
    v_pk_fma_f32 v[44:45], v[20:21], v[20:21], v[44:45]
    v_lshlrev_b32 v22, 16, v111
    v_and_b32 v23, 0xffff0000, v111
    v_pk_add_f32 v[38:39], v[38:39], v[22:23]
    v_pk_fma_f32 v[46:47], v[22:23], v[22:23], v[46:47]
    s_waitcnt vmcnt(3)
    v_lshlrev_b32 v20, 16, v112
    v_and_b32 v21, 0xffff0000, v112
    v_pk_add_f32 v[32:33], v[32:33], v[20:21]
    v_pk_fma_f32 v[40:41], v[20:21], v[20:21], v[40:41]
    v_lshlrev_b32 v22, 16, v113
    v_and_b32 v23, 0xffff0000, v113
    v_pk_add_f32 v[34:35], v[34:35], v[22:23]
    v_pk_fma_f32 v[42:43], v[22:23], v[22:23], v[42:43]
    v_lshlrev_b32 v20, 16, v114
    v_and_b32 v21, 0xffff0000, v114
    v_pk_add_f32 v[36:37], v[36:37], v[20:21]
    v_pk_fma_f32 v[44:45], v[20:21], v[20:21], v[44:45]
    v_lshlrev_b32 v22, 16, v115
    v_and_b32 v23, 0xffff0000, v115
    v_pk_add_f32 v[38:39], v[38:39], v[22:23]
    v_pk_fma_f32 v[46:47], v[22:23], v[22:23], v[46:47]
    s_waitcnt vmcnt(2)
    v_lshlrev_b32 v20, 16, v116
    v_and_b32 v21, 0xffff0000, v116
    v_pk_add_f32 v[32:33], v[32:33], v[20:21]
    v_pk_fma_f32 v[40:41], v[20:21], v[20:21], v[40:41]
    v_lshlrev_b32 v22, 16, v117
    v_and_b32 v23, 0xffff0000, v117
    v_pk_add_f32 v[34:35], v[34:35], v[22:23]
    v_pk_fma_f32 v[42:43], v[22:23], v[22:23], v[42:43]
    v_lshlrev_b32 v20, 16, v118
    v_and_b32 v21, 0xffff0000, v118
    v_pk_add_f32 v[36:37], v[36:37], v[20:21]
    v_pk_fma_f32 v[44:45], v[20:21], v[20:21], v[44:45]
    v_lshlrev_b32 v22, 16, v119
    v_and_b32 v23, 0xffff0000, v119
    v_pk_add_f32 v[38:39], v[38:39], v[22:23]
    v_pk_fma_f32 v[46:47], v[22:23], v[22:23], v[46:47]
    s_waitcnt vmcnt(1)
    v_lshlrev_b32 v20, 16, v120
    v_and_b32 v21, 0xffff0000, v120
    v_pk_add_f32 v[32:33], v[32:33], v[20:21]
    v_pk_fma_f32 v[40:41], v[20:21], v[20:21], v[40:41]
    v_lshlrev_b32 v22, 16, v121
    v_and_b32 v23, 0xffff0000, v121
    v_pk_add_f32 v[34:35], v[34:35], v[22:23]
    v_pk_fma_f32 v[42:43], v[22:23], v[22:23], v[42:43]
    v_lshlrev_b32 v20, 16, v122
    v_and_b32 v21, 0xffff0000, v122
    v_pk_add_f32 v[36:37], v[36:37], v[20:21]
    v_pk_fma_f32 v[44:45], v[20:21], v[20:21], v[44:45]
    v_lshlrev_b32 v22, 16, v123
    v_and_b32 v23, 0xffff0000, v123
    v_pk_add_f32 v[38:39], v[38:39], v[22:23]
    v_pk_fma_f32 v[46:47], v[22:23], v[22:23], v[46:47]
    s_waitcnt vmcnt(0)
    v_lshlrev_b32 v20, 16, v124
    v_and_b32 v21, 0xffff0000, v124
    v_pk_add_f32 v[32:33], v[32:33], v[20:21]
    v_pk_fma_f32 v[40:41], v[20:21], v[20:21], v[40:41]
    v_lshlrev_b32 v22, 16, v125
    v_and_b32 v23, 0xffff0000, v125
    v_pk_add_f32 v[34:35], v[34:35], v[22:23]
    v_pk_fma_f32 v[42:43], v[22:23], v[22:23], v[42:43]
    v_lshlrev_b32 v20, 16, v126
    v_and_b32 v21, 0xffff0000, v126
    v_pk_add_f32 v[36:37], v[36:37], v[20:21]
    v_pk_fma_f32 v[44:45], v[20:21], v[20:21], v[44:45]
    v_lshlrev_b32 v22, 16, v127
    v_and_b32 v23, 0xffff0000, v127
    v_pk_add_f32 v[38:39], v[38:39], v[22:23]
    v_pk_fma_f32 v[46:47], v[22:23], v[22:23], v[46:47]
    v_add_f32_dpp v32, v32, v32 row_ror:8 row_mask:0xf bank_mask:0xf
    v_add_f32_dpp v33, v33, v33 row_ror:8 row_mask:0xf bank_mask:0xf
    v_add_f32_dpp v34, v34, v34 row_ror:8 row_mask:0xf bank_mask:0xf
    v_add_f32_dpp v35, v35, v35 row_ror:8 row_mask:0xf bank_mask:0xf
    v_add_f32_dpp v36, v36, v36 row_ror:8 row_mask:0xf bank_mask:0xf
    v_add_f32_dpp v37, v37, v37 row_ror:8 row_mask:0xf bank_mask:0xf
    v_add_f32_dpp v38, v38, v38 row_ror:8 row_mask:0xf bank_mask:0xf
    v_add_f32_dpp v39, v39, v39 row_ror:8 row_mask:0xf bank_mask:0xf
    v_add_f32_dpp v40, v40, v40 row_ror:8 row_mask:0xf bank_mask:0xf
    v_add_f32_dpp v41, v41, v41 row_ror:8 row_mask:0xf bank_mask:0xf
    v_add_f32_dpp v42, v42, v42 row_ror:8 row_mask:0xf bank_mask:0xf
    v_add_f32_dpp v43, v43, v43 row_ror:8 row_mask:0xf bank_mask:0xf
    v_add_f32_dpp v44, v44, v44 row_ror:8 row_mask:0xf bank_mask:0xf
    v_add_f32_dpp v45, v45, v45 row_ror:8 row_mask:0xf bank_mask:0xf
    v_add_f32_dpp v46, v46, v46 row_ror:8 row_mask:0xf bank_mask:0xf
    v_add_f32_dpp v47, v47, v47 row_ror:8 row_mask:0xf bank_mask:0xf
    v_mov_b32 v48, v32
    v_mov_b32 v49, v33
    v_mov_b32 v50, v34
    v_mov_b32 v51, v35
    v_mov_b32 v52, v36
    v_mov_b32 v53, v37
    v_mov_b32 v54, v38
    v_mov_b32 v55, v39
    v_mov_b32 v56, v40
    v_mov_b32 v57, v41
    v_mov_b32 v58, v42
    v_mov_b32 v59, v43
    v_mov_b32 v60, v44
    v_mov_b32 v61, v45
    v_mov_b32 v62, v46
    v_mov_b32 v63, v47
    v_permlane16_swap_b32 v32, v48
    v_permlane16_swap_b32 v33, v49
    v_permlane16_swap_b32 v34, v50
    v_permlane16_swap_b32 v35, v51
    v_permlane16_swap_b32 v36, v52
    v_permlane16_swap_b32 v37, v53
    v_permlane16_swap_b32 v38, v54
    v_permlane16_swap_b32 v39, v55
    v_permlane16_swap_b32 v40, v56
    v_permlane16_swap_b32 v41, v57
    v_permlane16_swap_b32 v42, v58
    v_permlane16_swap_b32 v43, v59
    v_permlane16_swap_b32 v44, v60
    v_permlane16_swap_b32 v45, v61
    v_permlane16_swap_b32 v46, v62
    v_permlane16_swap_b32 v47, v63
    v_add_f32 v32, v32, v48
    v_add_f32 v33, v33, v49
    v_add_f32 v34, v34, v50
    v_add_f32 v35, v35, v51
    v_add_f32 v36, v36, v52
    v_add_f32 v37, v37, v53
    v_add_f32 v38, v38, v54
    v_add_f32 v39, v39, v55
    v_add_f32 v40, v40, v56
    v_add_f32 v41, v41, v57
    v_add_f32 v42, v42, v58
    v_add_f32 v43, v43, v59
    v_add_f32 v44, v44, v60
    v_add_f32 v45, v45, v61
    v_add_f32 v46, v46, v62
    v_add_f32 v47, v47, v63
    v_mov_b32 v48, v32
    v_mov_b32 v49, v33
    v_mov_b32 v50, v34
    v_mov_b32 v51, v35
    v_mov_b32 v52, v36
    v_mov_b32 v53, v37
    v_mov_b32 v54, v38
    v_mov_b32 v55, v39
    v_mov_b32 v56, v40
    v_mov_b32 v57, v41
    v_mov_b32 v58, v42
    v_mov_b32 v59, v43
    v_mov_b32 v60, v44
    v_mov_b32 v61, v45
    v_mov_b32 v62, v46
    v_mov_b32 v63, v47
    v_permlane32_swap_b32 v32, v48
    v_permlane32_swap_b32 v33, v49
    v_permlane32_swap_b32 v34, v50
    v_permlane32_swap_b32 v35, v51
    v_permlane32_swap_b32 v36, v52
    v_permlane32_swap_b32 v37, v53
    v_permlane32_swap_b32 v38, v54
    v_permlane32_swap_b32 v39, v55
    v_permlane32_swap_b32 v40, v56
    v_permlane32_swap_b32 v41, v57
    v_permlane32_swap_b32 v42, v58
    v_permlane32_swap_b32 v43, v59
    v_permlane32_swap_b32 v44, v60
    v_permlane32_swap_b32 v45, v61
    v_permlane32_swap_b32 v46, v62
    v_permlane32_swap_b32 v47, v63
    v_add_f32 v32, v32, v48
    v_add_f32 v33, v33, v49
    v_add_f32 v34, v34, v50
    v_add_f32 v35, v35, v51
    v_add_f32 v36, v36, v52
    v_add_f32 v37, v37, v53
    v_add_f32 v38, v38, v54
    v_add_f32 v39, v39, v55
    v_add_f32 v40, v40, v56
    v_add_f32 v41, v41, v57
    v_add_f32 v42, v42, v58
    v_add_f32 v43, v43, v59
    v_add_f32 v44, v44, v60
    v_add_f32 v45, v45, v61
    v_add_f32 v46, v46, v62
    v_add_f32 v47, v47, v63
    v_lshlrev_b32 v8, 6, v5
    s_lshl_b32 s79, s4, 9
    s_add_u32 s79, s79, 131072
    v_add_u32 v8, s79, v8
    s_mov_b64 exec, 0xff
    ds_write_b128 v8, v[32:35]
    ds_write_b128 v8, v[36:39] offset:16
    ds_write_b128 v8, v[40:43] offset:32
    ds_write_b128 v8, v[44:47] offset:48
    s_mov_b64 exec, -1
    s_waitcnt lgkmcnt(0)
    s_barrier
    s_cmp_lg_u32 s4, 0
    s_cbranch_scc1 NW34
    v_lshrrev_b32 v8, 3, v1
    v_lshlrev_b32 v8, 6, v8
    v_and_b32 v9, 7, v1
    v_lshl_add_u32 v8, v9, 2, v8
    v_add_u32 v8, 131072, v8
    ds_read_b32 v20, v8 offset:0
    ds_read_b32 v24, v8 offset:32
    ds_read_b32 v21, v8 offset:512
    ds_read_b32 v25, v8 offset:544
    ds_read_b32 v22, v8 offset:1024
    ds_read_b32 v26, v8 offset:1056
    ds_read_b32 v23, v8 offset:1536
    ds_read_b32 v27, v8 offset:1568
    s_waitcnt lgkmcnt(0)
    v_add_f32 v20, v20, v21
    v_add_f32 v22, v22, v23
    v_add_f32 v24, v24, v25
    v_add_f32 v26, v26, v27
    v_add_f32 v20, v20, v22
    v_add_f32 v24, v24, v26
    v_mul_f32 v20, 0x3b000000, v20
    v_mul_f32 v24, 0x3b000000, v24
    v_fma_f32 v24, -v20, v20, v24
    v_max_f32 v24, 0, v24
    v_cvt_pk_bf16_f32 v28, v24, v24
    v_lshlrev_b32 v24, 16, v28
    v_add_f32 v24, 0x3727c5ac, v24
    v_cvt_pk_bf16_f32 v28, v24, v24
    v_lshlrev_b32 v24, 16, v28
    v_sqrt_f32 v24, v24
    s_nop 0
    v_cvt_pk_bf16_f32 v28, v20, v24
    v_mov_b32 v29, s7
    v_lshlrev_b32 v8, 3, v1
    s_and_b32 s79, s11, 1
    s_lshl_b32 s79, s79, 10
    s_lshl_b32 s80, s76, 9
    s_add_u32 s79, s79, s80
    s_add_u32 s79, s79, s3
    s_add_u32 s79, s79, 2048
    buffer_store_dwordx2 v[28:29], v8, s[28:31], s79 offen sc1
NW34:
    s_barrier
    s_mul_i32 s88, s4, 56
    s_add_u32 s88, s88, 224
    v_min_u32 v20, 55, v1
    s_lshl_b32 s97, s23, 6
    s_add_u32 s97, s97, s88
    v_add_u32 v20, s97, v20
    v_subrev_u32 v21, 448, v20
    v_min_u32 v20, v20, v21
    v_lshlrev_b32 v20, 10, v20
    s_and_b32 s97, s6, 3
    s_mul_i32 s97, s97, 458752
    s_lshl_b32 s94, s15, 7
    s_add_u32 s97, s97, s94
    buffer_load_dword v21, v20, s[60:63], s97 offen sc1
    s_lshl_b32 s87, s4, 15
    v_add_u32 v12, s87, v3
    v_add_u32 v13, s87, v4
    s_mov_b32 m0, s87
    s_nop 0
    buffer_load_dwordx4 v2, s[60:63], s18 offen lds
    s_add_u32 s18, s18, 8192
    s_add_u32 m0, m0, 1024
    s_cmp_eq_u32 s18, s22
    s_cselect_b32 s97, 458752, 0
    s_sub_u32 s18, s18, s97
    buffer_load_dwordx4 v2, s[60:63], s18 offen lds
    s_add_u32 s18, s18, 8192
    s_add_u32 m0, m0, 1024
    s_cmp_eq_u32 s18, s22
    s_cselect_b32 s97, 458752, 0
    s_sub_u32 s18, s18, s97
    buffer_load_dwordx4 v2, s[60:63], s18 offen lds
    s_add_u32 s18, s18, 8192
    s_add_u32 m0, m0, 1024
    s_cmp_eq_u32 s18, s22
    s_cselect_b32 s97, 458752, 0
    s_sub_u32 s18, s18, s97
    buffer_load_dwordx4 v2, s[60:63], s18 offen lds
    s_add_u32 s18, s18, 8192
    s_add_u32 m0, m0, 1024
    s_cmp_eq_u32 s18, s22
    s_cselect_b32 s97, 458752, 0
    s_sub_u32 s18, s18, s97
    buffer_load_dwordx4 v2, s[60:63], s18 offen lds
    s_add_u32 s18, s18, 8192
    s_add_u32 m0, m0, 1024
    s_cmp_eq_u32 s18, s22
    s_cselect_b32 s97, 458752, 0
    s_sub_u32 s18, s18, s97
    buffer_load_dwordx4 v2, s[60:63], s18 offen lds
    s_add_u32 s18, s18, 8192
    s_add_u32 m0, m0, 1024
    s_cmp_eq_u32 s18, s22
    s_cselect_b32 s97, 458752, 0
    s_sub_u32 s18, s18, s97
    buffer_load_dwordx4 v2, s[60:63], s18 offen lds
    s_add_u32 s18, s18, 8192
    s_add_u32 m0, m0, 1024
    s_cmp_eq_u32 s18, s22
    s_cselect_b32 s97, 458752, 0
    s_sub_u32 s18, s18, s97
    buffer_load_dwordx4 v2, s[60:63], s18 offen lds
    s_add_u32 s18, s18, 8192
    s_add_u32 m0, m0, 1024
    s_cmp_eq_u32 s18, s22
    s_cselect_b32 s97, 458752, 0
    s_sub_u32 s18, s18, s97
    buffer_load_dwordx4 v2, s[60:63], s18 offen lds
    s_add_u32 s18, s18, 8192
    s_add_u32 m0, m0, 1024
    s_cmp_eq_u32 s18, s22
    s_cselect_b32 s97, 458752, 0
    s_sub_u32 s18, s18, s97
    buffer_load_dwordx4 v2, s[60:63], s18 offen lds
    s_add_u32 s18, s18, 8192
    s_add_u32 m0, m0, 1024
    s_cmp_eq_u32 s18, s22
    s_cselect_b32 s97, 458752, 0
    s_sub_u32 s18, s18, s97
    buffer_load_dwordx4 v2, s[60:63], s18 offen lds
    s_add_u32 s18, s18, 8192
    s_add_u32 m0, m0, 1024
    s_cmp_eq_u32 s18, s22
    s_cselect_b32 s97, 458752, 0
    s_sub_u32 s18, s18, s97
    buffer_load_dwordx4 v2, s[60:63], s18 offen lds
    s_add_u32 s18, s18, 8192
    s_add_u32 m0, m0, 1024
    s_cmp_eq_u32 s18, s22
    s_cselect_b32 s97, 458752, 0
    s_sub_u32 s18, s18, s97
    buffer_load_dwordx4 v2, s[60:63], s18 offen lds
    s_add_u32 s18, s18, 8192
    s_add_u32 m0, m0, 1024
    s_cmp_eq_u32 s18, s22
    s_cselect_b32 s97, 458752, 0
    s_sub_u32 s18, s18, s97
    buffer_load_dwordx4 v2, s[60:63], s18 offen lds
    s_add_u32 s18, s18, 8192
    s_add_u32 m0, m0, 1024
    s_cmp_eq_u32 s18, s22
    s_cselect_b32 s97, 458752, 0
    s_sub_u32 s18, s18, s97
    buffer_load_dwordx4 v2, s[60:63], s18 offen lds
    s_add_u32 s18, s18, 8192
    s_add_u32 m0, m0, 1024
    s_cmp_eq_u32 s18, s22
    s_cselect_b32 s97, 458752, 0
    s_sub_u32 s18, s18, s97
    buffer_load_dwordx4 v2, s[60:63], s18 offen lds
    s_add_u32 s18, s18, 8192
    s_add_u32 m0, m0, 1024
    s_cmp_eq_u32 s18, s22
    s_cselect_b32 s97, 458752, 0
    s_sub_u32 s18, s18, s97
    buffer_load_dwordx4 v2, s[60:63], s18 offen lds
    s_add_u32 s18, s18, 8192
    s_add_u32 m0, m0, 1024
    s_cmp_eq_u32 s18, s22
    s_cselect_b32 s97, 458752, 0
    s_sub_u32 s18, s18, s97
    buffer_load_dwordx4 v2, s[60:63], s18 offen lds
    s_add_u32 s18, s18, 8192
    s_add_u32 m0, m0, 1024
    s_cmp_eq_u32 s18, s22
    s_cselect_b32 s97, 458752, 0
    s_sub_u32 s18, s18, s97
    buffer_load_dwordx4 v2, s[60:63], s18 offen lds
    s_add_u32 s18, s18, 8192
    s_add_u32 m0, m0, 1024
    s_cmp_eq_u32 s18, s22
    s_cselect_b32 s97, 458752, 0
    s_sub_u32 s18, s18, s97
    buffer_load_dwordx4 v2, s[60:63], s18 offen lds
    s_add_u32 s18, s18, 8192
    s_add_u32 m0, m0, 1024
    s_cmp_eq_u32 s18, s22
    s_cselect_b32 s97, 458752, 0
    s_sub_u32 s18, s18, s97
    buffer_load_dwordx4 v2, s[60:63], s18 offen lds
    s_add_u32 s18, s18, 8192
    s_add_u32 m0, m0, 1024
    s_cmp_eq_u32 s18, s22
    s_cselect_b32 s97, 458752, 0
    s_sub_u32 s18, s18, s97
    buffer_load_dwordx4 v2, s[60:63], s18 offen lds
    s_add_u32 s18, s18, 8192
    s_add_u32 m0, m0, 1024
    s_cmp_eq_u32 s18, s22
    s_cselect_b32 s97, 458752, 0
    s_sub_u32 s18, s18, s97
    buffer_load_dwordx4 v2, s[60:63], s18 offen lds
    s_add_u32 s18, s18, 8192
    s_add_u32 m0, m0, 1024
    s_cmp_eq_u32 s18, s22
    s_cselect_b32 s97, 458752, 0
    s_sub_u32 s18, s18, s97
    buffer_load_dwordx4 v2, s[60:63], s18 offen lds
    s_add_u32 s18, s18, 8192
    s_add_u32 m0, m0, 1024
    s_cmp_eq_u32 s18, s22
    s_cselect_b32 s97, 458752, 0
    s_sub_u32 s18, s18, s97
    buffer_load_dwordx4 v2, s[60:63], s18 offen lds
    s_add_u32 s18, s18, 8192
    s_add_u32 m0, m0, 1024
    s_cmp_eq_u32 s18, s22
    s_cselect_b32 s97, 458752, 0
    s_sub_u32 s18, s18, s97
    buffer_load_dwordx4 v2, s[60:63], s18 offen lds
    s_add_u32 s18, s18, 8192
    s_add_u32 m0, m0, 1024
    s_cmp_eq_u32 s18, s22
    s_cselect_b32 s97, 458752, 0
    s_sub_u32 s18, s18, s97
    buffer_load_dwordx4 v2, s[60:63], s18 offen lds
    s_add_u32 s18, s18, 8192
    s_add_u32 m0, m0, 1024
    s_cmp_eq_u32 s18, s22
    s_cselect_b32 s97, 458752, 0
    s_sub_u32 s18, s18, s97
    buffer_load_dwordx4 v2, s[60:63], s18 offen lds
    s_add_u32 s18, s18, 8192
    s_add_u32 m0, m0, 1024
    s_cmp_eq_u32 s18, s22
    s_cselect_b32 s97, 458752, 0
    s_sub_u32 s18, s18, s97
    buffer_load_dwordx4 v2, s[60:63], s18 offen lds
    s_add_u32 s18, s18, 8192
    s_add_u32 m0, m0, 1024
    s_cmp_eq_u32 s18, s22
    s_cselect_b32 s97, 458752, 0
    s_sub_u32 s18, s18, s97
    buffer_load_dwordx4 v2, s[60:63], s18 offen lds
    s_add_u32 s18, s18, 8192
    s_add_u32 m0, m0, 1024
    s_cmp_eq_u32 s18, s22
    s_cselect_b32 s97, 458752, 0
    s_sub_u32 s18, s18, s97
    buffer_load_dwordx4 v2, s[60:63], s18 offen lds
    s_add_u32 s18, s18, 8192
    s_add_u32 m0, m0, 1024
    s_cmp_eq_u32 s18, s22
    s_cselect_b32 s97, 458752, 0
    s_sub_u32 s18, s18, s97
    buffer_load_dwordx4 v2, s[60:63], s18 offen lds
    s_add_u32 s18, s18, 8192
    s_add_u32 m0, m0, 1024
    s_cmp_eq_u32 s18, s22
    s_cselect_b32 s97, 458752, 0
    s_sub_u32 s18, s18, s97
    s_waitcnt vmcnt(0)
    ds_read_b64_tr_b16 a[80:81], v12 offset:0
    ds_read_b64_tr_b16 a[82:83], v12 offset:1024
    ds_read_b64_tr_b16 a[84:85], v13 offset:0
    ds_read_b64_tr_b16 a[86:87], v13 offset:1024
    ds_read_b64_tr_b16 a[88:89], v12 offset:2048
    ds_read_b64_tr_b16 a[90:91], v12 offset:3072
    ds_read_b64_tr_b16 a[92:93], v13 offset:2048
    ds_read_b64_tr_b16 a[94:95], v13 offset:3072
    ds_read_b64_tr_b16 a[96:97], v12 offset:4096
    ds_read_b64_tr_b16 a[98:99], v12 offset:5120
    ds_read_b64_tr_b16 a[100:101], v13 offset:4096
    ds_read_b64_tr_b16 a[102:103], v13 offset:5120
    ds_read_b64_tr_b16 a[104:105], v12 offset:6144
    ds_read_b64_tr_b16 a[106:107], v12 offset:7168
    ds_read_b64_tr_b16 a[108:109], v13 offset:6144
    ds_read_b64_tr_b16 a[110:111], v13 offset:7168
    ds_read_b64_tr_b16 a[112:113], v12 offset:8192
    ds_read_b64_tr_b16 a[114:115], v12 offset:9216
    ds_read_b64_tr_b16 a[116:117], v13 offset:8192
    ds_read_b64_tr_b16 a[118:119], v13 offset:9216
    ds_read_b64_tr_b16 a[120:121], v12 offset:10240
    ds_read_b64_tr_b16 a[122:123], v12 offset:11264
    ds_read_b64_tr_b16 a[124:125], v13 offset:10240
    ds_read_b64_tr_b16 a[126:127], v13 offset:11264
    ds_read_b64_tr_b16 a[128:129], v12 offset:12288
    ds_read_b64_tr_b16 a[130:131], v12 offset:13312
    ds_read_b64_tr_b16 a[132:133], v13 offset:12288
    ds_read_b64_tr_b16 a[134:135], v13 offset:13312
    ds_read_b64_tr_b16 a[136:137], v12 offset:14336
    ds_read_b64_tr_b16 a[138:139], v12 offset:15360
    ds_read_b64_tr_b16 a[140:141], v13 offset:14336
    ds_read_b64_tr_b16 a[142:143], v13 offset:15360
    ds_read_b64_tr_b16 a[144:145], v12 offset:16384
    ds_read_b64_tr_b16 a[146:147], v12 offset:17408
    ds_read_b64_tr_b16 a[148:149], v13 offset:16384
    ds_read_b64_tr_b16 a[150:151], v13 offset:17408
    ds_read_b64_tr_b16 a[152:153], v12 offset:18432
    ds_read_b64_tr_b16 a[154:155], v12 offset:19456
    ds_read_b64_tr_b16 a[156:157], v13 offset:18432
    ds_read_b64_tr_b16 a[158:159], v13 offset:19456
    ds_read_b64_tr_b16 a[160:161], v12 offset:20480
    ds_read_b64_tr_b16 a[162:163], v12 offset:21504
    ds_read_b64_tr_b16 a[164:165], v13 offset:20480
    ds_read_b64_tr_b16 a[166:167], v13 offset:21504
    ds_read_b64_tr_b16 a[168:169], v12 offset:22528
    ds_read_b64_tr_b16 a[170:171], v12 offset:23552
    ds_read_b64_tr_b16 a[172:173], v13 offset:22528
    ds_read_b64_tr_b16 a[174:175], v13 offset:23552
    ds_read_b64_tr_b16 a[176:177], v12 offset:24576
    ds_read_b64_tr_b16 a[178:179], v12 offset:25600
    ds_read_b64_tr_b16 a[180:181], v13 offset:24576
    ds_read_b64_tr_b16 a[182:183], v13 offset:25600
    ds_read_b64_tr_b16 a[184:185], v12 offset:26624
    ds_read_b64_tr_b16 a[186:187], v12 offset:27648
    ds_read_b64_tr_b16 a[188:189], v13 offset:26624
    ds_read_b64_tr_b16 a[190:191], v13 offset:27648
    ds_read_b64_tr_b16 a[192:193], v12 offset:28672
    ds_read_b64_tr_b16 a[194:195], v12 offset:29696
    ds_read_b64_tr_b16 a[196:197], v13 offset:28672
    ds_read_b64_tr_b16 a[198:199], v13 offset:29696
    ds_read_b64_tr_b16 a[200:201], v12 offset:30720
    ds_read_b64_tr_b16 a[202:203], v12 offset:31744
    ds_read_b64_tr_b16 a[204:205], v13 offset:30720
    ds_read_b64_tr_b16 a[206:207], v13 offset:31744
    s_waitcnt lgkmcnt(0)
    s_mov_b32 m0, s87
    s_nop 0
    buffer_load_dwordx4 v2, s[60:63], s18 offen lds
    s_add_u32 s18, s18, 8192
    s_add_u32 m0, m0, 1024
    s_cmp_eq_u32 s18, s22
    s_cselect_b32 s97, 458752, 0
    s_sub_u32 s18, s18, s97
    buffer_load_dwordx4 v2, s[60:63], s18 offen lds
    s_add_u32 s18, s18, 8192
    s_add_u32 m0, m0, 1024
    s_cmp_eq_u32 s18, s22
    s_cselect_b32 s97, 458752, 0
    s_sub_u32 s18, s18, s97
    buffer_load_dwordx4 v2, s[60:63], s18 offen lds
    s_add_u32 s18, s18, 8192
    s_add_u32 m0, m0, 1024
    s_cmp_eq_u32 s18, s22
    s_cselect_b32 s97, 458752, 0
    s_sub_u32 s18, s18, s97
    buffer_load_dwordx4 v2, s[60:63], s18 offen lds
    s_add_u32 s18, s18, 8192
    s_add_u32 m0, m0, 1024
    s_cmp_eq_u32 s18, s22
    s_cselect_b32 s97, 458752, 0
    s_sub_u32 s18, s18, s97
    s_waitcnt vmcnt(0)
    ds_read_b64_tr_b16 a[208:209], v12 offset:0
    ds_read_b64_tr_b16 a[210:211], v12 offset:1024
    ds_read_b64_tr_b16 a[212:213], v13 offset:0
    ds_read_b64_tr_b16 a[214:215], v13 offset:1024
    ds_read_b64_tr_b16 a[216:217], v12 offset:2048
    ds_read_b64_tr_b16 a[218:219], v12 offset:3072
    ds_read_b64_tr_b16 a[220:221], v13 offset:2048
    ds_read_b64_tr_b16 a[222:223], v13 offset:3072
    s_mov_b32 s95, 0
    v_lshlrev_b32 v247, 4, v1
    v_lshrrev_b32 v244, 2, v1
    v_and_b32 v245, 3, v1
    v_bfe_u32 v246, v244, 1, 1
    s_and_b32 s68, s17, 1
    v_xor_b32 v246, s68, v246
    v_lshlrev_b32 v246, 6, v246
    v_lshl_add_u32 v246, v245, 4, v246
    v_lshl_add_u32 v246, v244, 7, v246
    s_lshr_b32 s69, s17, 1
    s_lshl_b32 s70, s69, 16
    s_lshl_b32 s71, s16, 12
    s_add_u32 s70, s70, s71
    s_lshl_b32 s71, s9, 11
    s_add_u32 s70, s70, s71
    s_add_u32 s70, s70, 5242880
    s_add_u32 s71, s70, 64512
    s_lshl_b32 s21, s4, 11
    s_add_u32 s21, s21, 155648
    s_mov_b32 m0, s21
    s_nop 0
    buffer_load_dwordx4 v246, s[28:31], s70 offen sc1 lds
    buffer_load_dwordx4 v246, s[28:31], s71 offen offset:1024 sc1 lds
    s_mul_i32 s72, s4, 28672
    s_add_u32 s72, s72, 12582912
    s_mul_i32 s73, s17, 114688
    s_add_u32 s73, s73, s72
    s_add_u32 s75, s73, 28672
    s_lshl_b32 s88, s23, 12
    s_add_u32 s73, s73, s88
    v_min_u32 v244, 13, v1
    s_mul_i32 s74, s4, 56
    v_lshlrev_b32 v244, 2, v244
    s_and_b32 s69, s14, 1
    s_lshl_b32 s69, s69, 9
    s_add_u32 s69, s69, s74
    s_add_u32 s69, s69, s3
    s_add_u32 s69, s69, 1024
    v_add_u32 v248, s69, v244
    v_add_u32 v249, 256, v248
    s_mov_b32 s96, 0
POLL35:
    buffer_load_dword v250, v248, s[28:31], 0 offen sc1
    s_waitcnt vmcnt(0)
    v_cmp_ne_u32 vcc, s7, v250
    s_cbranch_vccz PDONE36
    s_add_u32 s96, s96, 1
    s_cmp_lt_u32 s96, 50000
    s_cbranch_scc1 POLL35
PDONE36:
P3_START:
    s_waitcnt lgkmcnt(0)
    buffer_load_dwordx4 v[128:131], v247, s[28:31], s73 offen offset:0 sc1
    buffer_load_dwordx4 v[132:135], v247, s[28:31], s73 offen offset:1024 sc1
    buffer_load_dwordx4 v[136:139], v247, s[28:31], s73 offen offset:2048 sc1
    buffer_load_dwordx4 v[140:143], v247, s[28:31], s73 offen offset:3072 sc1
    s_add_u32 s73, s73, 4096
    s_cmp_eq_u32 s73, s75
    s_cselect_b32 s88, 28672, 0
    s_sub_u32 s73, s73, s88
    buffer_load_dwordx4 v[144:147], v247, s[28:31], s73 offen offset:0 sc1
    buffer_load_dwordx4 v[148:151], v247, s[28:31], s73 offen offset:1024 sc1
    buffer_load_dwordx4 v[152:155], v247, s[28:31], s73 offen offset:2048 sc1
    buffer_load_dwordx4 v[156:159], v247, s[28:31], s73 offen offset:3072 sc1
    s_add_u32 s73, s73, 4096
    s_cmp_eq_u32 s73, s75
    s_cselect_b32 s88, 28672, 0
    s_sub_u32 s73, s73, s88
    buffer_load_dwordx4 v[160:163], v247, s[28:31], s73 offen offset:0 sc1
    buffer_load_dwordx4 v[164:167], v247, s[28:31], s73 offen offset:1024 sc1
    buffer_load_dwordx4 v[168:171], v247, s[28:31], s73 offen offset:2048 sc1
    buffer_load_dwordx4 v[172:175], v247, s[28:31], s73 offen offset:3072 sc1
    s_add_u32 s73, s73, 4096
    s_cmp_eq_u32 s73, s75
    s_cselect_b32 s88, 28672, 0
    s_sub_u32 s73, s73, s88
    buffer_load_dwordx4 v[176:179], v247, s[28:31], s73 offen offset:0 sc1
    buffer_load_dwordx4 v[180:183], v247, s[28:31], s73 offen offset:1024 sc1
    v_bfe_u32 v5, v1, 2, 2
    v_and_b32 v6, 3, v1
    v_bfe_u32 v7, v1, 4, 1
    v_lshrrev_b32 v8, 5, v1
    v_lshlrev_b32 v9, 2, v8
    v_add_u32 v9, v9, v5
    v_lshlrev_b32 v9, 6, v9
    v_lshl_add_u32 v9, v7, 5, v9
    v_lshl_add_u32 v9, v6, 3, v9
    v_add_u32 v9, s21, v9
    v_and_b32 v5, 31, v1
    v_lshlrev_b32 v5, 10, v5
    v_lshl_add_u32 v5, v8, 4, v5
    s_lshl_b32 s77, s17, 15
    s_lshl_b32 s78, s16, 6
    s_add_u32 s77, s77, s78
    s_lshl_b32 s78, s9, 5
    s_add_u32 s77, s77, s78
    s_add_u32 s78, s77, 65536
    s_mul_i32 s76, s4, 6144
    s_add_u32 s76, s76, 131072
    v_add_u32 v10, s76, v247
    s_xor_b32 s76, s4, 1
    s_mul_i32 s76, s76, 6144
    s_add_u32 s76, s76, 131072
    v_add_u32 v11, s76, v247
    s_xor_b32 s76, s4, 2
    s_mul_i32 s76, s76, 6144
    s_add_u32 s76, s76, 133120
    v_add_u32 v12, s76, v247
    s_xor_b32 s76, s4, 3
    s_mul_i32 s76, s76, 6144
    s_add_u32 s76, s76, 135168
    v_add_u32 v13, s76, v247
    s_barrier
    s_waitcnt vmcnt(13)
    s_cmp_eq_u32 s95, 0
    s_cbranch_scc1 LT37
    v_mov_b32 v14, s7
    s_mov_b64 exec, 1
    s_cmp_eq_u32 s26, 0
    s_cbranch_scc1 FS38
    buffer_store_dword v14, off, s[28:31], s82
    s_branch FS39
FS38:
    buffer_store_dword v14, off, s[28:31], s82 sc1
FS39:
    s_mov_b64 exec, -1
    ds_read_b64_tr_b16 a[160:161], v15 offset:0
    ds_read_b64_tr_b16 a[162:163], v15 offset:1024
    ds_read_b64_tr_b16 a[164:165], v16 offset:0
    ds_read_b64_tr_b16 a[166:167], v16 offset:1024
    ds_read_b64_tr_b16 a[168:169], v15 offset:2048
    ds_read_b64_tr_b16 a[170:171], v15 offset:3072
    ds_read_b64_tr_b16 a[172:173], v16 offset:2048
    ds_read_b64_tr_b16 a[174:175], v16 offset:3072
    ds_read_b64_tr_b16 a[176:177], v15 offset:4096
    ds_read_b64_tr_b16 a[178:179], v15 offset:5120
    ds_read_b64_tr_b16 a[180:181], v16 offset:4096
    ds_read_b64_tr_b16 a[182:183], v16 offset:5120
    ds_read_b64_tr_b16 a[184:185], v15 offset:6144
    ds_read_b64_tr_b16 a[186:187], v15 offset:7168
    ds_read_b64_tr_b16 a[188:189], v16 offset:6144
    ds_read_b64_tr_b16 a[190:191], v16 offset:7168
    ds_read_b64_tr_b16 a[192:193], v15 offset:8192
    ds_read_b64_tr_b16 a[194:195], v15 offset:9216
    ds_read_b64_tr_b16 a[196:197], v16 offset:8192
    ds_read_b64_tr_b16 a[198:199], v16 offset:9216
    ds_read_b64_tr_b16 a[200:201], v15 offset:10240
    ds_read_b64_tr_b16 a[202:203], v15 offset:11264
    ds_read_b64_tr_b16 a[204:205], v16 offset:10240
    ds_read_b64_tr_b16 a[206:207], v16 offset:11264
    ds_read_b64_tr_b16 a[208:209], v15 offset:12288
    ds_read_b64_tr_b16 a[210:211], v15 offset:13312
    ds_read_b64_tr_b16 a[212:213], v16 offset:12288
    ds_read_b64_tr_b16 a[214:215], v16 offset:13312
    ds_read_b64_tr_b16 a[216:217], v15 offset:14336
    ds_read_b64_tr_b16 a[218:219], v15 offset:15360
    ds_read_b64_tr_b16 a[220:221], v16 offset:14336
    ds_read_b64_tr_b16 a[222:223], v16 offset:15360
LT37:
    v_mfma_f32_32x32x16_bf16 v[64:79], a[0:3], v[128:131], 0
    buffer_load_dwordx4 v[184:187], v247, s[28:31], s73 offen offset:2048 sc1
    v_mfma_f32_32x32x16_bf16 v[80:95], a[4:7], v[128:131], 0
    s_waitcnt vmcnt(13)
    v_mfma_f32_32x32x16_bf16 v[64:79], a[8:11], v[132:135], v[64:79]
    buffer_load_dwordx4 v[188:191], v247, s[28:31], s73 offen offset:3072 sc1
    s_add_u32 s73, s73, 4096
    s_cmp_eq_u32 s73, s75
    s_cselect_b32 s88, 28672, 0
    s_sub_u32 s73, s73, s88
    v_mfma_f32_32x32x16_bf16 v[80:95], a[12:15], v[132:135], v[80:95]
    s_waitcnt vmcnt(13)
    v_mfma_f32_32x32x16_bf16 v[64:79], a[16:19], v[136:139], v[64:79]
    buffer_load_dwordx4 v[192:195], v247, s[28:31], s73 offen offset:0 sc1
    v_mfma_f32_32x32x16_bf16 v[80:95], a[20:23], v[136:139], v[80:95]
    s_waitcnt vmcnt(13)
    v_mfma_f32_32x32x16_bf16 v[64:79], a[24:27], v[140:143], v[64:79]
    buffer_load_dwordx4 v[196:199], v247, s[28:31], s73 offen offset:1024 sc1
    v_mfma_f32_32x32x16_bf16 v[80:95], a[28:31], v[140:143], v[80:95]
    s_waitcnt vmcnt(13)
    v_mfma_f32_32x32x16_bf16 v[64:79], a[32:35], v[144:147], v[64:79]
    buffer_load_dwordx4 v[200:203], v247, s[28:31], s73 offen offset:2048 sc1
    v_mfma_f32_32x32x16_bf16 v[80:95], a[36:39], v[144:147], v[80:95]
    s_waitcnt vmcnt(13)
    v_mfma_f32_32x32x16_bf16 v[64:79], a[40:43], v[148:151], v[64:79]
    buffer_load_dwordx4 v[204:207], v247, s[28:31], s73 offen offset:3072 sc1
    s_add_u32 s73, s73, 4096
    s_cmp_eq_u32 s73, s75
    s_cselect_b32 s88, 28672, 0
    s_sub_u32 s73, s73, s88
    v_mfma_f32_32x32x16_bf16 v[80:95], a[44:47], v[148:151], v[80:95]
    s_waitcnt vmcnt(13)
    v_mfma_f32_32x32x16_bf16 v[64:79], a[48:51], v[152:155], v[64:79]
    buffer_load_dwordx4 v[208:211], v247, s[28:31], s73 offen offset:0 sc1
    v_mfma_f32_32x32x16_bf16 v[80:95], a[52:55], v[152:155], v[80:95]
    s_waitcnt vmcnt(13)
    v_mfma_f32_32x32x16_bf16 v[64:79], a[56:59], v[156:159], v[64:79]
    buffer_load_dwordx4 v[212:215], v247, s[28:31], s73 offen offset:1024 sc1
    v_mfma_f32_32x32x16_bf16 v[80:95], a[60:63], v[156:159], v[80:95]
    s_waitcnt vmcnt(13)
    v_mfma_f32_32x32x16_bf16 v[64:79], a[64:67], v[160:163], v[64:79]
    buffer_load_dwordx4 v[216:219], v247, s[28:31], s73 offen offset:2048 sc1
    v_mfma_f32_32x32x16_bf16 v[80:95], a[68:71], v[160:163], v[80:95]
    s_waitcnt vmcnt(13)
    v_mfma_f32_32x32x16_bf16 v[64:79], a[72:75], v[164:167], v[64:79]
    buffer_load_dwordx4 v[220:223], v247, s[28:31], s73 offen offset:3072 sc1
    s_add_u32 s73, s73, 4096
    s_cmp_eq_u32 s73, s75
    s_cselect_b32 s88, 28672, 0
    s_sub_u32 s73, s73, s88
    v_mfma_f32_32x32x16_bf16 v[80:95], a[76:79], v[164:167], v[80:95]
    s_waitcnt vmcnt(13)
    v_mfma_f32_32x32x16_bf16 v[64:79], a[80:83], v[168:171], v[64:79]
    buffer_load_dword v6, v249, s[28:31], 0 offen sc1
    buffer_load_dwordx4 v[128:131], v247, s[28:31], s73 offen offset:0 sc1
    v_mfma_f32_32x32x16_bf16 v[80:95], a[84:87], v[168:171], v[80:95]
    s_waitcnt vmcnt(14)
    v_mfma_f32_32x32x16_bf16 v[64:79], a[88:91], v[172:175], v[64:79]
    buffer_load_dwordx4 v[132:135], v247, s[28:31], s73 offen offset:1024 sc1
    v_mfma_f32_32x32x16_bf16 v[80:95], a[92:95], v[172:175], v[80:95]
    s_waitcnt vmcnt(14)
    v_mfma_f32_32x32x16_bf16 v[64:79], a[96:99], v[176:179], v[64:79]
    buffer_load_dwordx4 v[136:139], v247, s[28:31], s73 offen offset:2048 sc1
    v_mfma_f32_32x32x16_bf16 v[80:95], a[100:103], v[176:179], v[80:95]
    s_waitcnt vmcnt(14)
    v_mfma_f32_32x32x16_bf16 v[64:79], a[104:107], v[180:183], v[64:79]
    buffer_load_dwordx4 v[140:143], v247, s[28:31], s73 offen offset:3072 sc1
    s_add_u32 s73, s73, 4096
    s_cmp_eq_u32 s73, s75
    s_cselect_b32 s88, 28672, 0
    s_sub_u32 s73, s73, s88
    s_add_u32 s73, s73, 229376
    s_add_u32 s75, s75, 229376
    v_mfma_f32_32x32x16_bf16 v[80:95], a[108:111], v[180:183], v[80:95]
    s_waitcnt vmcnt(14)
    v_mfma_f32_32x32x16_bf16 v[64:79], a[112:115], v[184:187], v[64:79]
    s_waitcnt vmcnt(4)
    v_cmp_ne_u32 vcc, s7, v6
    s_cbranch_vccz FCOK40
    s_mov_b32 s96, 0
POLL41:
    buffer_load_dword v6, v249, s[28:31], 0 offen sc1
    s_waitcnt vmcnt(0)
    v_cmp_ne_u32 vcc, s7, v6
    s_cbranch_vccz PDONE42
    s_add_u32 s96, s96, 1
    s_cmp_lt_u32 s96, 50000
    s_cbranch_scc1 POLL41
PDONE42:
FCOK40:
    buffer_load_dwordx4 v[144:147], v247, s[28:31], s73 offen offset:0 sc1
    v_mfma_f32_32x32x16_bf16 v[80:95], a[116:119], v[184:187], v[80:95]
    v_mfma_f32_32x32x16_bf16 v[64:79], a[120:123], v[188:191], v[64:79]
    buffer_load_dwordx4 v[148:151], v247, s[28:31], s73 offen offset:1024 sc1
    v_mfma_f32_32x32x16_bf16 v[80:95], a[124:127], v[188:191], v[80:95]
    s_waitcnt lgkmcnt(0)
    v_mfma_f32_32x32x16_bf16 v[64:79], a[128:131], v[192:195], v[64:79]
    buffer_load_dwordx4 v[152:155], v247, s[28:31], s73 offen offset:2048 sc1
    v_mfma_f32_32x32x16_bf16 v[80:95], a[132:135], v[192:195], v[80:95]
    v_mfma_f32_32x32x16_bf16 v[64:79], a[136:139], v[196:199], v[64:79]
    buffer_load_dwordx4 v[156:159], v247, s[28:31], s73 offen offset:3072 sc1
    s_add_u32 s73, s73, 4096
    s_cmp_eq_u32 s73, s75
    s_cselect_b32 s88, 28672, 0
    s_sub_u32 s73, s73, s88
    v_mfma_f32_32x32x16_bf16 v[80:95], a[140:143], v[196:199], v[80:95]
    v_mfma_f32_32x32x16_bf16 v[64:79], a[144:147], v[200:203], v[64:79]
    buffer_load_dwordx4 v[160:163], v247, s[28:31], s73 offen offset:0 sc1
    v_mfma_f32_32x32x16_bf16 v[80:95], a[148:151], v[200:203], v[80:95]
    v_mfma_f32_32x32x16_bf16 v[64:79], a[152:155], v[204:207], v[64:79]
    buffer_load_dwordx4 v[164:167], v247, s[28:31], s73 offen offset:1024 sc1
    v_mfma_f32_32x32x16_bf16 v[80:95], a[156:159], v[204:207], v[80:95]
    v_mfma_f32_32x32x16_bf16 v[64:79], a[160:163], v[208:211], v[64:79]
    buffer_load_dwordx4 v[168:171], v247, s[28:31], s73 offen offset:2048 sc1
    v_mfma_f32_32x32x16_bf16 v[80:95], a[164:167], v[208:211], v[80:95]
    v_mfma_f32_32x32x16_bf16 v[64:79], a[168:171], v[212:215], v[64:79]
    buffer_load_dwordx4 v[172:175], v247, s[28:31], s73 offen offset:3072 sc1
    s_add_u32 s73, s73, 4096
    s_cmp_eq_u32 s73, s75
    s_cselect_b32 s88, 28672, 0
    s_sub_u32 s73, s73, s88
    v_mfma_f32_32x32x16_bf16 v[80:95], a[172:175], v[212:215], v[80:95]
    v_mfma_f32_32x32x16_bf16 v[64:79], a[176:179], v[216:219], v[64:79]
    buffer_load_dwordx4 v[176:179], v247, s[28:31], s73 offen offset:0 sc1
    v_mfma_f32_32x32x16_bf16 v[80:95], a[180:183], v[216:219], v[80:95]
    v_mfma_f32_32x32x16_bf16 v[64:79], a[184:187], v[220:223], v[64:79]
    buffer_load_dwordx4 v[180:183], v247, s[28:31], s73 offen offset:1024 sc1
    v_mfma_f32_32x32x16_bf16 v[80:95], a[188:191], v[220:223], v[80:95]
    s_waitcnt vmcnt(13)
    v_mfma_f32_32x32x16_bf16 v[64:79], a[192:195], v[128:131], v[64:79]
    buffer_load_dwordx4 v[184:187], v247, s[28:31], s73 offen offset:2048 sc1
    v_mfma_f32_32x32x16_bf16 v[80:95], a[196:199], v[128:131], v[80:95]
    s_waitcnt vmcnt(13)
    v_mfma_f32_32x32x16_bf16 v[64:79], a[200:203], v[132:135], v[64:79]
    buffer_load_dwordx4 v[188:191], v247, s[28:31], s73 offen offset:3072 sc1
    s_add_u32 s73, s73, 4096
    s_cmp_eq_u32 s73, s75
    s_cselect_b32 s88, 28672, 0
    s_sub_u32 s73, s73, s88
    v_mfma_f32_32x32x16_bf16 v[80:95], a[204:207], v[132:135], v[80:95]
    s_waitcnt vmcnt(13)
    v_mfma_f32_32x32x16_bf16 v[64:79], a[208:211], v[136:139], v[64:79]
    buffer_load_dwordx4 v[192:195], v247, s[28:31], s73 offen offset:0 sc1
    v_mfma_f32_32x32x16_bf16 v[80:95], a[212:215], v[136:139], v[80:95]
    s_waitcnt vmcnt(13)
    v_mfma_f32_32x32x16_bf16 v[80:95], a[220:223], v[140:143], v[80:95]
    buffer_load_dwordx4 v[196:199], v247, s[28:31], s73 offen offset:1024 sc1
    v_mfma_f32_32x32x16_bf16 v[64:79], a[216:219], v[140:143], v[64:79]
    s_waitcnt vmcnt(13)
    s_cmp_eq_u32 s9, 0
    s_cbranch_scc0 RP43
    s_nop 6
    ds_write_b128 v13, v[88:91] offset:0
    ds_write_b128 v13, v[92:95] offset:1024
    ds_write_b128 v12, v[80:83] offset:0
    ds_write_b128 v12, v[84:87] offset:1024
    ds_write_b128 v11, v[72:75] offset:0
    ds_write_b128 v11, v[76:79] offset:1024
    v_mov_b64 v[48:49], v[64:65]
    v_mov_b64 v[50:51], v[66:67]
    v_mov_b64 v[52:53], v[68:69]
    v_mov_b64 v[54:55], v[70:71]
    s_branch RP44
RP43:
    s_nop 7
    s_nop 3
    ds_write_b128 v13, v[80:83] offset:0
    ds_write_b128 v13, v[84:87] offset:1024
    ds_write_b128 v12, v[88:91] offset:0
    ds_write_b128 v12, v[92:95] offset:1024
    ds_write_b128 v11, v[64:67] offset:0
    ds_write_b128 v11, v[68:71] offset:1024
    v_mov_b64 v[48:49], v[72:73]
    v_mov_b64 v[50:51], v[74:75]
    v_mov_b64 v[52:53], v[76:77]
    v_mov_b64 v[54:55], v[78:79]
RP44:
    v_mfma_f32_32x32x16_bf16 v[96:111], a[0:3], v[144:147], 0
    buffer_load_dwordx4 v[200:203], v247, s[28:31], s73 offen offset:2048 sc1
    v_mfma_f32_32x32x16_bf16 v[112:127], a[4:7], v[144:147], 0
    s_waitcnt vmcnt(13)
    v_mfma_f32_32x32x16_bf16 v[96:111], a[8:11], v[148:151], v[96:111]
    buffer_load_dwordx4 v[204:207], v247, s[28:31], s73 offen offset:3072 sc1
    s_add_u32 s73, s73, 4096
    s_cmp_eq_u32 s73, s75
    s_cselect_b32 s88, 28672, 0
    s_sub_u32 s73, s73, s88
    v_mfma_f32_32x32x16_bf16 v[112:127], a[12:15], v[148:151], v[112:127]
    s_waitcnt vmcnt(13)
    v_mfma_f32_32x32x16_bf16 v[96:111], a[16:19], v[152:155], v[96:111]
    buffer_load_dwordx4 v[208:211], v247, s[28:31], s73 offen offset:0 sc1
    v_mfma_f32_32x32x16_bf16 v[112:127], a[20:23], v[152:155], v[112:127]
    s_waitcnt vmcnt(13)
    v_mfma_f32_32x32x16_bf16 v[96:111], a[24:27], v[156:159], v[96:111]
    buffer_load_dwordx4 v[212:215], v247, s[28:31], s73 offen offset:1024 sc1
    v_mfma_f32_32x32x16_bf16 v[112:127], a[28:31], v[156:159], v[112:127]
    s_waitcnt vmcnt(13)
    s_waitcnt lgkmcnt(0)
    s_barrier
    v_mfma_f32_32x32x16_bf16 v[96:111], a[32:35], v[160:163], v[96:111]
    buffer_load_dwordx4 v[216:219], v247, s[28:31], s73 offen offset:2048 sc1
    ds_read_b128 v[24:27], v10 offset:0
    ds_read_b128 v[28:31], v10 offset:1024
    ds_read_b128 v[32:35], v10 offset:2048
    ds_read_b128 v[36:39], v10 offset:3072
    v_mfma_f32_32x32x16_bf16 v[112:127], a[36:39], v[160:163], v[112:127]
    ds_read_b128 v[40:43], v10 offset:4096
    ds_read_b128 v[44:47], v10 offset:5120
    ds_read_b64_tr_b16 v[20:21], v9 offset:0
    ds_read_b64_tr_b16 v[22:23], v9 offset:512
    s_waitcnt vmcnt(13)
    v_mfma_f32_32x32x16_bf16 v[96:111], a[40:43], v[164:167], v[96:111]
    buffer_load_dwordx4 v[220:223], v247, s[28:31], s73 offen offset:3072 sc1
    s_add_u32 s73, s73, 4096
    s_cmp_eq_u32 s73, s75
    s_cselect_b32 s88, 28672, 0
    s_sub_u32 s73, s73, s88
    s_waitcnt lgkmcnt(0)
    v_lshlrev_b32 v56, 16, v20
    v_and_b32 v57, 0xffff0000, v20
    v_lshlrev_b32 v58, 16, v21
    v_mfma_f32_32x32x16_bf16 v[112:127], a[44:47], v[164:167], v[112:127]
    v_and_b32 v59, 0xffff0000, v21
    v_lshlrev_b32 v60, 16, v22
    v_and_b32 v61, 0xffff0000, v22
    v_lshlrev_b32 v62, 16, v23
    s_waitcnt vmcnt(13)
    v_mfma_f32_32x32x16_bf16 v[96:111], a[48:51], v[168:171], v[96:111]
    buffer_load_dwordx4 v[128:131], v247, s[28:31], s73 offen offset:0 sc1
    v_and_b32 v63, 0xffff0000, v23
    v_add_f32 v48, v48, v56
    v_add_f32 v49, v49, v57
    v_add_f32 v50, v50, v58
    v_mfma_f32_32x32x16_bf16 v[112:127], a[52:55], v[168:171], v[112:127]
    v_add_f32 v51, v51, v59
    v_add_f32 v52, v52, v60
    v_add_f32 v53, v53, v61
    v_add_f32 v54, v54, v62
    s_waitcnt vmcnt(13)
    v_mfma_f32_32x32x16_bf16 v[96:111], a[56:59], v[172:175], v[96:111]
    buffer_load_dwordx4 v[132:135], v247, s[28:31], s73 offen offset:1024 sc1
    v_add_f32 v55, v55, v63
    v_add_f32 v24, v24, v32
    v_add_f32 v25, v25, v33
    v_add_f32 v26, v26, v34
    v_mfma_f32_32x32x16_bf16 v[112:127], a[60:63], v[172:175], v[112:127]
    v_add_f32 v27, v27, v35
    v_add_f32 v28, v28, v36
    v_add_f32 v29, v29, v37
    v_add_f32 v30, v30, v38
    s_waitcnt vmcnt(13)
    v_mfma_f32_32x32x16_bf16 v[96:111], a[64:67], v[176:179], v[96:111]
    buffer_load_dwordx4 v[136:139], v247, s[28:31], s73 offen offset:2048 sc1
    v_add_f32 v31, v31, v39
    v_add_f32 v48, v48, v40
    v_add_f32 v49, v49, v41
    v_add_f32 v50, v50, v42
    v_mfma_f32_32x32x16_bf16 v[112:127], a[68:71], v[176:179], v[112:127]
    v_add_f32 v51, v51, v43
    v_add_f32 v52, v52, v44
    v_add_f32 v53, v53, v45
    v_add_f32 v54, v54, v46
    s_waitcnt vmcnt(13)
    v_mfma_f32_32x32x16_bf16 v[96:111], a[72:75], v[180:183], v[96:111]
    buffer_load_dwordx4 v[140:143], v247, s[28:31], s73 offen offset:3072 sc1
    s_add_u32 s73, s73, 4096
    s_cmp_eq_u32 s73, s75
    s_cselect_b32 s88, 28672, 0
    s_sub_u32 s73, s73, s88
    v_add_f32 v55, v55, v47
    v_add_f32 v48, v48, v24
    v_add_f32 v49, v49, v25
    v_add_f32 v50, v50, v26
    v_mfma_f32_32x32x16_bf16 v[112:127], a[76:79], v[180:183], v[112:127]
    v_add_f32 v51, v51, v27
    v_add_f32 v52, v52, v28
    v_add_f32 v53, v53, v29
    v_add_f32 v54, v54, v30
    s_waitcnt vmcnt(13)
    v_mfma_f32_32x32x16_bf16 v[96:111], a[80:83], v[184:187], v[96:111]
    buffer_load_dwordx4 v[144:147], v247, s[28:31], s73 offen offset:0 sc1
    v_add_f32 v55, v55, v31
    v_cvt_pk_bf16_f32 v56, v48, v49
    v_cvt_pk_bf16_f32 v57, v50, v51
    v_cvt_pk_bf16_f32 v58, v52, v53
    v_mfma_f32_32x32x16_bf16 v[112:127], a[84:87], v[184:187], v[112:127]
    v_cvt_pk_bf16_f32 v59, v54, v55
    v_permlane32_swap_b32 v56, v58
    s_nop 0
    v_permlane32_swap_b32 v57, v59
    buffer_store_dwordx4 v[56:59], v5, s[64:67], s77 offen
    s_waitcnt vmcnt(14)
    v_mfma_f32_32x32x16_bf16 v[96:111], a[88:91], v[188:191], v[96:111]
    buffer_load_dwordx4 v[148:151], v247, s[28:31], s73 offen offset:1024 sc1
    v_mfma_f32_32x32x16_bf16 v[112:127], a[92:95], v[188:191], v[112:127]
    s_waitcnt vmcnt(14)
    v_mfma_f32_32x32x16_bf16 v[96:111], a[96:99], v[192:195], v[96:111]
    buffer_load_dwordx4 v[152:155], v247, s[28:31], s73 offen offset:2048 sc1
    v_mfma_f32_32x32x16_bf16 v[112:127], a[100:103], v[192:195], v[112:127]
    s_waitcnt vmcnt(14)
    v_mfma_f32_32x32x16_bf16 v[96:111], a[104:107], v[196:199], v[96:111]
    buffer_load_dwordx4 v[156:159], v247, s[28:31], s73 offen offset:3072 sc1
    s_add_u32 s73, s73, 4096
    s_cmp_eq_u32 s73, s75
    s_cselect_b32 s88, 28672, 0
    s_sub_u32 s73, s73, s88
    v_mfma_f32_32x32x16_bf16 v[112:127], a[108:111], v[196:199], v[112:127]
    s_waitcnt vmcnt(14)
    v_mfma_f32_32x32x16_bf16 v[96:111], a[112:115], v[200:203], v[96:111]
    v_mfma_f32_32x32x16_bf16 v[112:127], a[116:119], v[200:203], v[112:127]
    s_waitcnt vmcnt(13)
    v_mfma_f32_32x32x16_bf16 v[96:111], a[120:123], v[204:207], v[96:111]
    v_mfma_f32_32x32x16_bf16 v[112:127], a[124:127], v[204:207], v[112:127]
    s_waitcnt vmcnt(12)
    v_mfma_f32_32x32x16_bf16 v[96:111], a[128:131], v[208:211], v[96:111]
    v_mfma_f32_32x32x16_bf16 v[112:127], a[132:135], v[208:211], v[112:127]
    s_waitcnt vmcnt(11)
    v_mfma_f32_32x32x16_bf16 v[96:111], a[136:139], v[212:215], v[96:111]
    v_mfma_f32_32x32x16_bf16 v[112:127], a[140:143], v[212:215], v[112:127]
    s_waitcnt vmcnt(10)
    v_mfma_f32_32x32x16_bf16 v[96:111], a[144:147], v[216:219], v[96:111]
    v_mfma_f32_32x32x16_bf16 v[112:127], a[148:151], v[216:219], v[112:127]
    s_waitcnt vmcnt(9)
    v_mfma_f32_32x32x16_bf16 v[96:111], a[152:155], v[220:223], v[96:111]
    v_mfma_f32_32x32x16_bf16 v[112:127], a[156:159], v[220:223], v[112:127]
    s_waitcnt vmcnt(8)
    v_mfma_f32_32x32x16_bf16 v[96:111], a[160:163], v[128:131], v[96:111]
    v_mfma_f32_32x32x16_bf16 v[112:127], a[164:167], v[128:131], v[112:127]
    s_waitcnt vmcnt(7)
    v_mfma_f32_32x32x16_bf16 v[96:111], a[168:171], v[132:135], v[96:111]
    v_mfma_f32_32x32x16_bf16 v[112:127], a[172:175], v[132:135], v[112:127]
    s_waitcnt vmcnt(6)
    v_mfma_f32_32x32x16_bf16 v[96:111], a[176:179], v[136:139], v[96:111]
    v_mfma_f32_32x32x16_bf16 v[112:127], a[180:183], v[136:139], v[112:127]
    s_waitcnt vmcnt(5)
    v_mfma_f32_32x32x16_bf16 v[96:111], a[184:187], v[140:143], v[96:111]
    v_mfma_f32_32x32x16_bf16 v[112:127], a[188:191], v[140:143], v[112:127]
    s_waitcnt vmcnt(4)
    v_mfma_f32_32x32x16_bf16 v[96:111], a[192:195], v[144:147], v[96:111]
    v_mfma_f32_32x32x16_bf16 v[112:127], a[196:199], v[144:147], v[112:127]
    s_waitcnt vmcnt(2)
    v_mfma_f32_32x32x16_bf16 v[96:111], a[200:203], v[148:151], v[96:111]
    v_mfma_f32_32x32x16_bf16 v[112:127], a[204:207], v[148:151], v[112:127]
    s_waitcnt vmcnt(1)
    v_mfma_f32_32x32x16_bf16 v[96:111], a[208:211], v[152:155], v[96:111]
    v_mfma_f32_32x32x16_bf16 v[112:127], a[212:215], v[152:155], v[112:127]
    s_waitcnt vmcnt(0)
    v_mfma_f32_32x32x16_bf16 v[112:127], a[220:223], v[156:159], v[112:127]
    v_mfma_f32_32x32x16_bf16 v[96:111], a[216:219], v[156:159], v[96:111]
    s_barrier
    s_cmp_eq_u32 s9, 0
    s_cbranch_scc0 RP45
    s_nop 7
    ds_write_b128 v13, v[120:123] offset:0
    ds_write_b128 v13, v[124:127] offset:1024
    ds_write_b128 v12, v[112:115] offset:0
    ds_write_b128 v12, v[116:119] offset:1024
    ds_write_b128 v11, v[104:107] offset:0
    ds_write_b128 v11, v[108:111] offset:1024
    v_mov_b64 v[48:49], v[96:97]
    v_mov_b64 v[50:51], v[98:99]
    v_mov_b64 v[52:53], v[100:101]
    v_mov_b64 v[54:55], v[102:103]
    s_branch RP46
RP45:
    s_nop 7
    s_nop 3
    ds_write_b128 v13, v[112:115] offset:0
    ds_write_b128 v13, v[116:119] offset:1024
    ds_write_b128 v12, v[120:123] offset:0
    ds_write_b128 v12, v[124:127] offset:1024
    ds_write_b128 v11, v[96:99] offset:0
    ds_write_b128 v11, v[100:103] offset:1024
    v_mov_b64 v[48:49], v[104:105]
    v_mov_b64 v[50:51], v[106:107]
    v_mov_b64 v[52:53], v[108:109]
    v_mov_b64 v[54:55], v[110:111]
RP46:
    s_waitcnt lgkmcnt(0)
    s_barrier
    ds_read_b128 v[24:27], v10 offset:0
    ds_read_b128 v[28:31], v10 offset:1024
    ds_read_b128 v[32:35], v10 offset:2048
    ds_read_b128 v[36:39], v10 offset:3072
    ds_read_b128 v[40:43], v10 offset:4096
    ds_read_b128 v[44:47], v10 offset:5120
    ds_read_b64_tr_b16 v[20:21], v9 offset:1024
    ds_read_b64_tr_b16 v[22:23], v9 offset:1536
    s_waitcnt lgkmcnt(0)
    v_lshlrev_b32 v56, 16, v20
    v_and_b32 v57, 0xffff0000, v20
    v_lshlrev_b32 v58, 16, v21
    v_and_b32 v59, 0xffff0000, v21
    v_lshlrev_b32 v60, 16, v22
    v_and_b32 v61, 0xffff0000, v22
    v_lshlrev_b32 v62, 16, v23
    v_and_b32 v63, 0xffff0000, v23
    v_add_f32 v48, v48, v56
    v_add_f32 v49, v49, v57
    v_add_f32 v50, v50, v58
    v_add_f32 v51, v51, v59
    v_add_f32 v52, v52, v60
    v_add_f32 v53, v53, v61
    v_add_f32 v54, v54, v62
    v_add_f32 v55, v55, v63
    v_add_f32 v24, v24, v32
    v_add_f32 v25, v25, v33
    v_add_f32 v26, v26, v34
    v_add_f32 v27, v27, v35
    v_add_f32 v28, v28, v36
    v_add_f32 v29, v29, v37
    v_add_f32 v30, v30, v38
    v_add_f32 v31, v31, v39
    v_add_f32 v48, v48, v40
    v_add_f32 v49, v49, v41
    v_add_f32 v50, v50, v42
    v_add_f32 v51, v51, v43
    v_add_f32 v52, v52, v44
    v_add_f32 v53, v53, v45
    v_add_f32 v54, v54, v46
    v_add_f32 v55, v55, v47
    v_add_f32 v48, v48, v24
    v_add_f32 v49, v49, v25
    v_add_f32 v50, v50, v26
    v_add_f32 v51, v51, v27
    v_add_f32 v52, v52, v28
    v_add_f32 v53, v53, v29
    v_add_f32 v54, v54, v30
    v_add_f32 v55, v55, v31
    v_cvt_pk_bf16_f32 v56, v48, v49
    v_cvt_pk_bf16_f32 v57, v50, v51
    v_cvt_pk_bf16_f32 v58, v52, v53
    v_cvt_pk_bf16_f32 v59, v54, v55
    s_nop 0
    v_permlane32_swap_b32 v56, v58
    v_permlane32_swap_b32 v57, v59
    buffer_store_dwordx4 v[56:59], v5, s[64:67], s78 offen
K_END:
    s_endpgm

.fill 256, 4, 0xbf800000
.section .rodata,"a"
.p2align 6
.amdhsa_kernel sequential_preLN__ssm_conv_h3__dense_activation_silu__prompt_kernel
  .amdhsa_next_free_vgpr 512
  .amdhsa_next_free_sgpr 102
  .amdhsa_accum_offset 256
  .amdhsa_group_segment_fixed_size 0
  .amdhsa_kernarg_size 96
  .amdhsa_user_sgpr_count 2
  .amdhsa_user_sgpr_kernarg_segment_ptr 1
  .amdhsa_system_sgpr_workgroup_id_x 1
.end_amdhsa_kernel
```
